```python
import torch

def _softmax(x, axis=-1):
    return torch.softmax(x, dim=axis)

def _gelu(x):
    return torch.nn.functional.gelu(x, approximate='tanh')

def _silu(x):
    return torch.nn.functional.silu(x)

def _sigmoid(x):
    return torch.sigmoid(x)

def _layernorm(x, axis=-1, eps=1e-05):
    m = x.mean(dim=axis, keepdim=True)
    v = x.var(dim=axis, keepdim=True, unbiased=False)
    return (x - m) / torch.sqrt(v + eps)

def _scatter_add(tgt, idx, src, axis=0):
    return tgt.clone().index_add_(axis, idx, src)

def _segment_sum(src, seg, n):
    out = torch.zeros((n,) + src.shape[1:], dtype=src.dtype)
    return out.index_add_(0, seg, src)

def _pad(x, pw):
    flat = tuple((v for pair in reversed(pw) for v in pair))
    return torch.nn.functional.pad(x, flat)
kernel_name = 'standalone__tree_speculative_verify_tree_attention_over_candidate_token_tree__sampling'

def setup_inputs():

    _w = lambda a: (lambda t: t.to(torch.bfloat16) if t.is_floating_point() else t)(torch.as_tensor(a))
    B, Hq, Hkv, T, C, D = (16, 32, 4, 1, 4096, 128)
    tree_mask = torch.zeros((B, T, T), dtype=float)
    for b in range(B):
        parent = torch.zeros(T, dtype=torch.int64)
        for i in range(1, T):
            parent[i] = int(torch.randint(0, i, (1,)).item())
        for i in range(T):
            j = i
            tree_mask[b, i, j] = 1.0
            while j > 0:
                j = parent[j]
                tree_mask[b, i, j] = 1.0
    return {'q': _w((lambda *s: torch.randn(*s, dtype=torch.bfloat16) * 0.8)(B, Hq, T, D)), 'k_cache': _w((lambda *s: torch.randn(*s, dtype=torch.bfloat16) * 0.8)(B, Hkv, C, D)), 'v_cache': _w((lambda *s: torch.randn(*s, dtype=torch.bfloat16) * 0.05)(B, Hkv, C, D)), 'k_tree': _w((lambda *s: torch.randn(*s, dtype=torch.bfloat16) * 0.8)(B, Hkv, T, D)), 'v_tree': _w((lambda *s: torch.randn(*s, dtype=torch.bfloat16) * 0.05)(B, Hkv, T, D)), 'tree_mask': _w(tree_mask)}

def reference(q, k_cache, v_cache, k_tree, v_tree, tree_mask):
    B, Hq, T, D = q.shape
    Hkv, C = (k_cache.shape[1], k_cache.shape[2])
    rep = Hq // Hkv
    kc = (lambda x, n, axis: torch.repeat_interleave(x, n, dim=axis))(k_cache, rep, axis=1)
    vc = (lambda x, n, axis: torch.repeat_interleave(x, n, dim=axis))(v_cache, rep, axis=1)
    kt = (lambda x, n, axis: torch.repeat_interleave(x, n, dim=axis))(k_tree, rep, axis=1)
    vt = (lambda x, n, axis: torch.repeat_interleave(x, n, dim=axis))(v_tree, rep, axis=1)
    k = torch.concatenate([kc, kt], axis=2)
    v = torch.concatenate([vc, vt], axis=2)
    scale = D ** (-0.5)
    scores = torch.einsum('bhqd,bhkd->bhqk', q, k) * scale
    ctx_mask = torch.ones((B, 1, T, C), dtype=scores.dtype)
    tm = tree_mask[:, None, :, :].clone()
    full_mask = torch.concatenate([ctx_mask, tm], axis=-1)
    scores = scores + (1.0 - full_mask) * -1000000000.0
    p = _softmax(scores, axis=-1)
    return torch.einsum('bhqk,bhkd->bhqd', p, v)
```

```asm
; @launch grid=(256,1,1) block=(256,1,1) lds=21392
.amdgcn_target "amdgcn-amd-amdhsa--gfx950"
.text
.globl standalone__tree_speculative_verify_tree_attention_over_candidate_token_tree__sampling_kernel
.p2align 8
.type standalone__tree_speculative_verify_tree_attention_over_candidate_token_tree__sampling_kernel,@function
standalone__tree_speculative_verify_tree_attention_over_candidate_token_tree__sampling_kernel:
  s_load_dwordx16 s[4:19], s[0:1], 0
  s_load_dwordx2 s[20:21], s[0:1], 64
  s_cmp_ge_u32 s2, 256
  s_cbranch_scc1 L_end
  v_lshrrev_b32 v4, 6, v0
  v_and_b32 v1, 63, v0
  v_readfirstlane_b32 s3, v4
  s_and_b32 s53, s2, 0x2
  s_lshl_b32 s53, s53, 6
  s_bitcmp1_b32 s2, 0
  s_cselect_b32 s55, 0x45, 0
  s_xor_b32 s53, s53, s55
  s_bitcmp1_b32 s2, 2
  s_cselect_b32 s55, 0x2000, 0
  s_xor_b32 s53, s53, s55
  s_bitcmp1_b32 s2, 3
  s_cselect_b32 s55, 0x126, 0
  s_xor_b32 s53, s53, s55
  s_bitcmp1_b32 s2, 4
  s_cselect_b32 s55, 0x1000, 0
  s_xor_b32 s53, s53, s55
  s_bitcmp1_b32 s2, 5
  s_cselect_b32 s55, 0x400, 0
  s_xor_b32 s53, s53, s55
  s_bitcmp1_b32 s2, 6
  s_cselect_b32 s55, 0x800, 0
  s_xor_b32 s53, s53, s55
  s_bitcmp1_b32 s2, 7
  s_cselect_b32 s55, 0x200, 0
  s_xor_b32 s53, s53, s55
  s_bfe_u32 s23, s2, 0x10000
  s_bfe_u32 s55, s2, 0x10001
  s_lshl_b32 s55, s55, 1
  s_or_b32 s23, s23, s55
  s_bitcmp1_b32 s3, 0
  s_cselect_b32 s55, 0x1, 0
  s_xor_b32 s53, s53, s55
  s_bitcmp1_b32 s3, 1
  s_cselect_b32 s55, 0x13, 0
  s_xor_b32 s53, s53, s55
  s_lshr_b32 s22, s53, 8
  s_and_b32 s32, s53, 0xff
  s_lshl_b32 s32, s32, 12
  v_mov_b32 v4, 0
  v_bfe_u32 v5, v0, 2, 3
  v_lshl_add_u32 v2, v5, 8, v4
  v_bfe_u32 v5, v0, 5, 1
  v_lshl_add_u32 v2, v5, 6, v2
  v_and_b32 v6, 3, v0
  v_lshl_add_u32 v2, v6, 4, v2
  v_lshl_add_u32 v3, v5, 8, v4
  v_bfe_u32 v6, v0, 4, 1
  v_lshl_add_u32 v3, v6, 11, v3
  v_and_b32 v6, 15, v0
  v_lshl_add_u32 v3, v6, 4, v3
  v_and_b32 v6, 7, v0
  v_lshlrev_b32 v6, 8, v6
  v_lshl_add_u32 v6, v5, 6, v6
  v_bfe_u32 v7, v0, 3, 2
  v_lshl_add_u32 v6, v7, 4, v6
  s_lshl_b32 s52, s22, 11
  v_add_u32 v6, s52, v6
  s_lshl_b32 s53, s22, 20
  s_mov_b32 s26, 0x100000
  s_mov_b32 s27, 0x20000
  s_mov_b32 s30, 0x100000
  s_mov_b32 s31, 0x20000
  s_mov_b32 s56, s32
  s_waitcnt lgkmcnt(0)
  s_add_u32 s24, s6, s53
  s_addc_u32 s25, s7, 0
  buffer_load_dwordx4 v[48:51], v2, s[24:27], s56 offen offset:0 nt
  global_load_dwordx4 v[12:15], v6, s[4:5]
  global_load_dwordx4 v[16:19], v6, s[4:5] offset:128
  buffer_load_dwordx4 v[52:55], v2, s[24:27], s56 offen offset:128 nt
  buffer_load_dwordx4 v[56:59], v2, s[24:27], s56 offen offset:2048 nt
  buffer_load_dwordx4 v[60:63], v2, s[24:27], s56 offen offset:2176 nt
  s_xor_b32 s56, s32, 0x18000
  buffer_load_dwordx4 v[64:67], v2, s[24:27], s56 offen offset:0 nt
  buffer_load_dwordx4 v[68:71], v2, s[24:27], s56 offen offset:128 nt
  s_or_b32 s55, s2, s3
  s_cmp_lg_u32 s55, 0
  s_cbranch_scc1 L_nonce_done
  s_mov_b32 s66, 1
  s_mov_b32 s67, 0xff80000
  s_atomic_add s66, s[20:21], s67 glc
  s_waitcnt lgkmcnt(0)
  s_add_u32 s66, s66, 1
  s_and_b32 s66, s66, 0xffff
  s_or_b32 s66, s66, 0x10000
  s_atomic_add s66, s[18:19], 0x0
L_nonce_done:
  s_add_u32 s28, s8, s53
  s_addc_u32 s29, s9, 0
  s_add_u32 s36, s20, 0xfc00000
  s_addc_u32 s37, s21, 0
  s_mov_b32 s39, 0x20000
  s_mov_b32 s44, s16
  s_mov_b32 s45, s17
  s_mov_b32 s46, 0x20000
  s_mov_b32 s47, 0x20000
  s_mov_b32 s48, 0xff00ff00
  s_mov_b32 s49, 0xff00ff00
  s_mov_b32 s50, 0xffff0000
  s_mov_b32 s51, 0xffff0000
  s_mov_b32 s60, 0x05040100
  s_mov_b32 s61, 0x07060302
  s_mov_b32 s62, 0x3e0293ee
  s_mov_b32 s68, 0xffffff00
  s_lshr_b32 s54, s22, 2
  s_lshl_b32 s55, s54, 1
  s_and_b32 s55, s55, 0x1c
  s_load_dword s33, s[14:15], s55
  s_lshl_b32 s64, s22, 2
  s_add_u32 s64, s64, s3
  s_lshl_b32 s65, s64, 13
  s_lshl_b32 s43, s64, 8
  s_add_u32 s43, s43, 0xff00000
  s_mul_i32 s67, s23, 1536
  s_add_u32 s67, s67, s65
  s_xor_b32 s64, s23, 1
  s_mul_i32 s64, s64, 1536
  s_add_u32 s64, s64, s65
  s_xor_b32 s66, s23, 2
  s_mul_i32 s66, s66, 1536
  s_add_u32 s66, s66, s65
  s_xor_b32 s55, s23, 3
  s_mul_i32 s55, s55, 1536
  s_add_u32 s65, s55, s65
  v_lshlrev_b32 v36, 4, v1
  v_mov_b32 v39, 0
  s_lshl_b32 s69, s3, 1
  v_lshrrev_b32 v6, 5, v1
  v_add_u32 v6, s69, v6
  v_and_b32 v7, 31, v1
  v_lshlrev_b32 v7, 3, v7
  v_lshl_add_u32 v37, v6, 8, v7
  v_add_u32 v37, s52, v37
  s_lshl_b32 s55, s22, 8
  v_add_u32 v35, s55, v7
  v_bfe_u32 v4, v1, 3, 2
  v_and_b32 v5, 7, v1
  v_mul_u32_u24 v34, 528, v6
  v_lshlrev_b32 v38, 4, v6
  v_add_u32 v38, 16896, v38
  v_mul_u32_u24 v4, 128, v4
  v_lshl_add_u32 v4, v5, 4, v4
  v_add_u32 v34, v4, v34
  v_mul_u32_u24 v33, 528, v5
  v_lshrrev_b32 v4, 4, v1
  v_mul_u32_u24 v4, 128, v4
  s_mul_i32 s55, s3, 4224
  v_mov_b32 v6, s55
  v_mov_b32 v7, 17156
  v_cndmask_b32 v6, v6, v7, s[48:49]
  v_add3_u32 v33, v6, v33, v4
  v_lshlrev_b32 v0, 4, v5
  v_add_u32 v0, 16896, v0
  s_lshl_b32 s58, s3, 2
  v_mov_b32 v30, 0xff800000
  v_mov_b32 v31, 0
  s_waitcnt vmcnt(5)
  buffer_load_dwordx4 v[72:75], v2, s[24:27], s56 offen offset:2048 nt
  v_mfma_f32_32x32x16_bf16 v[96:111], v[48:51], v[12:15], 0
  s_waitcnt vmcnt(5)
  buffer_load_dwordx4 v[76:79], v2, s[24:27], s56 offen offset:2176 nt
  v_mfma_f32_32x32x16_bf16 v[96:111], v[52:55], v[16:19], v[96:111]
  s_waitcnt vmcnt(5)
  s_xor_b32 s56, s32, 0x8000
  buffer_load_dwordx4 v[80:83], v2, s[24:27], s56 offen offset:0 nt
  v_mfma_f32_32x32x16_bf16 v[112:127], v[56:59], v[12:15], 0
  s_waitcnt vmcnt(5)
  buffer_load_dwordx4 v[84:87], v2, s[24:27], s56 offen offset:128 nt
  v_mfma_f32_32x32x16_bf16 v[112:127], v[60:63], v[16:19], v[112:127]
  s_waitcnt vmcnt(5)
  buffer_load_dwordx4 v[88:91], v2, s[24:27], s56 offen offset:2048 nt
  v_mfma_f32_32x32x16_bf16 v[192:207], v[64:67], v[12:15], 0
  s_nop 3
  v_cndmask_b32 v4, v96, v97, s[48:49]
  v_cndmask_b32 v5, v98, v99, s[48:49]
  v_cndmask_b32 v40, v4, v5, s[50:51]
  v_cndmask_b32 v4, v100, v101, s[48:49]
  v_cndmask_b32 v5, v102, v103, s[48:49]
  v_cndmask_b32 v41, v4, v5, s[50:51]
  v_cndmask_b32 v4, v104, v105, s[48:49]
  v_cndmask_b32 v5, v106, v107, s[48:49]
  v_cndmask_b32 v42, v4, v5, s[50:51]
  v_cndmask_b32 v4, v108, v109, s[48:49]
  v_cndmask_b32 v5, v110, v111, s[48:49]
  v_cndmask_b32 v43, v4, v5, s[50:51]
  s_waitcnt vmcnt(5)
  buffer_load_dwordx4 v[92:95], v2, s[24:27], s56 offen offset:2176 nt
  v_mfma_f32_32x32x16_bf16 v[192:207], v[68:71], v[16:19], v[192:207]
  v_cndmask_b32 v4, v112, v113, s[48:49]
  v_cndmask_b32 v5, v114, v115, s[48:49]
  v_cndmask_b32 v44, v4, v5, s[50:51]
  v_cndmask_b32 v4, v116, v117, s[48:49]
  v_cndmask_b32 v5, v118, v119, s[48:49]
  v_cndmask_b32 v45, v4, v5, s[50:51]
  v_cndmask_b32 v4, v120, v121, s[48:49]
  v_cndmask_b32 v5, v122, v123, s[48:49]
  v_cndmask_b32 v46, v4, v5, s[50:51]
  v_cndmask_b32 v4, v124, v125, s[48:49]
  v_cndmask_b32 v5, v126, v127, s[48:49]
  v_cndmask_b32 v47, v4, v5, s[50:51]
  s_waitcnt vmcnt(5)
  s_xor_b32 s56, s32, 0x10000
  buffer_load_dwordx4 v[48:51], v2, s[24:27], s56 offen offset:0 nt
  v_mfma_f32_32x32x16_bf16 v[208:223], v[72:75], v[12:15], 0
  v_permlane16_swap_b32 v40, v44
  v_permlane16_swap_b32 v41, v45
  v_permlane16_swap_b32 v42, v46
  v_permlane16_swap_b32 v43, v47
  s_nop 0
  v_add_f32 v40, v40, v44
  v_add_f32 v41, v41, v45
  v_add_f32 v42, v42, v46
  v_add_f32 v43, v43, v47
  s_waitcnt vmcnt(5)
  buffer_load_dwordx4 v[52:55], v2, s[24:27], s56 offen offset:128 nt
  v_mfma_f32_32x32x16_bf16 v[208:223], v[76:79], v[16:19], v[208:223]
  v_add_f32_dpp v128, v40, v40 row_ror:8 row_mask:0xf bank_mask:0xf
  v_add_f32_dpp v129, v41, v41 row_ror:8 row_mask:0xf bank_mask:0xf
  v_add_f32_dpp v130, v42, v42 row_ror:8 row_mask:0xf bank_mask:0xf
  v_add_f32_dpp v131, v43, v43 row_ror:8 row_mask:0xf bank_mask:0xf
  v_max3_f32 v30, v30, v128, v129
  v_max3_f32 v30, v30, v130, v131
  s_waitcnt vmcnt(5)
  buffer_load_dwordx4 v[56:59], v2, s[24:27], s56 offen offset:2048 nt
  v_mfma_f32_32x32x16_bf16 v[96:111], v[80:83], v[12:15], 0
  s_nop 3
  v_cndmask_b32 v4, v192, v193, s[48:49]
  v_cndmask_b32 v5, v194, v195, s[48:49]
  v_cndmask_b32 v40, v4, v5, s[50:51]
  v_cndmask_b32 v4, v196, v197, s[48:49]
  v_cndmask_b32 v5, v198, v199, s[48:49]
  v_cndmask_b32 v41, v4, v5, s[50:51]
  v_cndmask_b32 v4, v200, v201, s[48:49]
  v_cndmask_b32 v5, v202, v203, s[48:49]
  v_cndmask_b32 v42, v4, v5, s[50:51]
  v_cndmask_b32 v4, v204, v205, s[48:49]
  v_cndmask_b32 v5, v206, v207, s[48:49]
  v_cndmask_b32 v43, v4, v5, s[50:51]
  s_waitcnt vmcnt(5)
  buffer_load_dwordx4 v[60:63], v2, s[24:27], s56 offen offset:2176 nt
  v_mfma_f32_32x32x16_bf16 v[96:111], v[84:87], v[16:19], v[96:111]
  v_cndmask_b32 v4, v208, v209, s[48:49]
  v_cndmask_b32 v5, v210, v211, s[48:49]
  v_cndmask_b32 v44, v4, v5, s[50:51]
  v_cndmask_b32 v4, v212, v213, s[48:49]
  v_cndmask_b32 v5, v214, v215, s[48:49]
  v_cndmask_b32 v45, v4, v5, s[50:51]
  v_cndmask_b32 v4, v216, v217, s[48:49]
  v_cndmask_b32 v5, v218, v219, s[48:49]
  v_cndmask_b32 v46, v4, v5, s[50:51]
  v_cndmask_b32 v4, v220, v221, s[48:49]
  v_cndmask_b32 v5, v222, v223, s[48:49]
  v_cndmask_b32 v47, v4, v5, s[50:51]
  s_waitcnt vmcnt(5)
  s_xor_b32 s56, s32, 0x8c000
  buffer_load_dwordx4 v[64:67], v2, s[24:27], s56 offen offset:0 nt
  v_mfma_f32_32x32x16_bf16 v[112:127], v[88:91], v[12:15], 0
  v_permlane16_swap_b32 v40, v44
  v_permlane16_swap_b32 v41, v45
  v_permlane16_swap_b32 v42, v46
  v_permlane16_swap_b32 v43, v47
  s_nop 0
  v_add_f32 v40, v40, v44
  v_add_f32 v41, v41, v45
  v_add_f32 v42, v42, v46
  v_add_f32 v43, v43, v47
  s_waitcnt vmcnt(5)
  buffer_load_dwordx4 v[68:71], v2, s[24:27], s56 offen offset:128 nt
  v_mfma_f32_32x32x16_bf16 v[112:127], v[92:95], v[16:19], v[112:127]
  v_add_f32_dpp v132, v40, v40 row_ror:8 row_mask:0xf bank_mask:0xf
  v_add_f32_dpp v133, v41, v41 row_ror:8 row_mask:0xf bank_mask:0xf
  v_add_f32_dpp v134, v42, v42 row_ror:8 row_mask:0xf bank_mask:0xf
  v_add_f32_dpp v135, v43, v43 row_ror:8 row_mask:0xf bank_mask:0xf
  v_max3_f32 v30, v30, v132, v133
  v_max3_f32 v30, v30, v134, v135
  s_waitcnt vmcnt(5)
  buffer_load_dwordx4 v[72:75], v2, s[24:27], s56 offen offset:2048 nt
  v_mfma_f32_32x32x16_bf16 v[192:207], v[48:51], v[12:15], 0
  s_nop 3
  v_cndmask_b32 v4, v96, v97, s[48:49]
  v_cndmask_b32 v5, v98, v99, s[48:49]
  v_cndmask_b32 v40, v4, v5, s[50:51]
  v_cndmask_b32 v4, v100, v101, s[48:49]
  v_cndmask_b32 v5, v102, v103, s[48:49]
  v_cndmask_b32 v41, v4, v5, s[50:51]
  v_cndmask_b32 v4, v104, v105, s[48:49]
  v_cndmask_b32 v5, v106, v107, s[48:49]
  v_cndmask_b32 v42, v4, v5, s[50:51]
  v_cndmask_b32 v4, v108, v109, s[48:49]
  v_cndmask_b32 v5, v110, v111, s[48:49]
  v_cndmask_b32 v43, v4, v5, s[50:51]
  s_waitcnt vmcnt(5)
  buffer_load_dwordx4 v[76:79], v2, s[24:27], s56 offen offset:2176 nt
  v_mfma_f32_32x32x16_bf16 v[192:207], v[52:55], v[16:19], v[192:207]
  v_cndmask_b32 v4, v112, v113, s[48:49]
  v_cndmask_b32 v5, v114, v115, s[48:49]
  v_cndmask_b32 v44, v4, v5, s[50:51]
  v_cndmask_b32 v4, v116, v117, s[48:49]
  v_cndmask_b32 v5, v118, v119, s[48:49]
  v_cndmask_b32 v45, v4, v5, s[50:51]
  v_cndmask_b32 v4, v120, v121, s[48:49]
  v_cndmask_b32 v5, v122, v123, s[48:49]
  v_cndmask_b32 v46, v4, v5, s[50:51]
  v_cndmask_b32 v4, v124, v125, s[48:49]
  v_cndmask_b32 v5, v126, v127, s[48:49]
  v_cndmask_b32 v47, v4, v5, s[50:51]
  s_waitcnt vmcnt(5)
  s_xor_b32 s56, s32, 0x94000
  buffer_load_dwordx4 v[80:83], v2, s[24:27], s56 offen offset:0 nt
  v_mfma_f32_32x32x16_bf16 v[208:223], v[56:59], v[12:15], 0
  v_permlane16_swap_b32 v40, v44
  v_permlane16_swap_b32 v41, v45
  v_permlane16_swap_b32 v42, v46
  v_permlane16_swap_b32 v43, v47
  s_nop 0
  v_add_f32 v40, v40, v44
  v_add_f32 v41, v41, v45
  v_add_f32 v42, v42, v46
  v_add_f32 v43, v43, v47
  s_waitcnt vmcnt(5)
  buffer_load_dwordx4 v[84:87], v2, s[24:27], s56 offen offset:128 nt
  v_mfma_f32_32x32x16_bf16 v[208:223], v[60:63], v[16:19], v[208:223]
  v_add_f32_dpp v136, v40, v40 row_ror:8 row_mask:0xf bank_mask:0xf
  v_add_f32_dpp v137, v41, v41 row_ror:8 row_mask:0xf bank_mask:0xf
  v_add_f32_dpp v138, v42, v42 row_ror:8 row_mask:0xf bank_mask:0xf
  v_add_f32_dpp v139, v43, v43 row_ror:8 row_mask:0xf bank_mask:0xf
  v_max3_f32 v30, v30, v136, v137
  v_max3_f32 v30, v30, v138, v139
  s_waitcnt vmcnt(5)
  buffer_load_dwordx4 v[88:91], v2, s[24:27], s56 offen offset:2048 nt
  v_mfma_f32_32x32x16_bf16 v[96:111], v[64:67], v[12:15], 0
  s_nop 3
  v_cndmask_b32 v4, v192, v193, s[48:49]
  v_cndmask_b32 v5, v194, v195, s[48:49]
  v_cndmask_b32 v40, v4, v5, s[50:51]
  v_cndmask_b32 v4, v196, v197, s[48:49]
  v_cndmask_b32 v5, v198, v199, s[48:49]
  v_cndmask_b32 v41, v4, v5, s[50:51]
  v_cndmask_b32 v4, v200, v201, s[48:49]
  v_cndmask_b32 v5, v202, v203, s[48:49]
  v_cndmask_b32 v42, v4, v5, s[50:51]
  v_cndmask_b32 v4, v204, v205, s[48:49]
  v_cndmask_b32 v5, v206, v207, s[48:49]
  v_cndmask_b32 v43, v4, v5, s[50:51]
  s_waitcnt vmcnt(5)
  buffer_load_dwordx4 v[92:95], v2, s[24:27], s56 offen offset:2176 nt
  v_mfma_f32_32x32x16_bf16 v[96:111], v[68:71], v[16:19], v[96:111]
  v_cndmask_b32 v4, v208, v209, s[48:49]
  v_cndmask_b32 v5, v210, v211, s[48:49]
  v_cndmask_b32 v44, v4, v5, s[50:51]
  v_cndmask_b32 v4, v212, v213, s[48:49]
  v_cndmask_b32 v5, v214, v215, s[48:49]
  v_cndmask_b32 v45, v4, v5, s[50:51]
  v_cndmask_b32 v4, v216, v217, s[48:49]
  v_cndmask_b32 v5, v218, v219, s[48:49]
  v_cndmask_b32 v46, v4, v5, s[50:51]
  v_cndmask_b32 v4, v220, v221, s[48:49]
  v_cndmask_b32 v5, v222, v223, s[48:49]
  v_cndmask_b32 v47, v4, v5, s[50:51]
  s_waitcnt vmcnt(5)
  s_xor_b32 s56, s32, 0x84000
  buffer_load_dwordx4 v[48:51], v2, s[24:27], s56 offen offset:0 nt
  v_mfma_f32_32x32x16_bf16 v[112:127], v[72:75], v[12:15], 0
  v_permlane16_swap_b32 v40, v44
  v_permlane16_swap_b32 v41, v45
  v_permlane16_swap_b32 v42, v46
  v_permlane16_swap_b32 v43, v47
  s_nop 0
  v_add_f32 v40, v40, v44
  v_add_f32 v41, v41, v45
  v_add_f32 v42, v42, v46
  v_add_f32 v43, v43, v47
  s_waitcnt vmcnt(5)
  buffer_load_dwordx4 v[52:55], v2, s[24:27], s56 offen offset:128 nt
  v_mfma_f32_32x32x16_bf16 v[112:127], v[76:79], v[16:19], v[112:127]
  v_add_f32_dpp v140, v40, v40 row_ror:8 row_mask:0xf bank_mask:0xf
  v_add_f32_dpp v141, v41, v41 row_ror:8 row_mask:0xf bank_mask:0xf
  v_add_f32_dpp v142, v42, v42 row_ror:8 row_mask:0xf bank_mask:0xf
  v_add_f32_dpp v143, v43, v43 row_ror:8 row_mask:0xf bank_mask:0xf
  v_max3_f32 v30, v30, v140, v141
  v_max3_f32 v30, v30, v142, v143
  s_waitcnt vmcnt(5)
  global_load_dwordx2 v[20:21], v37, s[4:5]
  global_load_dwordx2 v[22:23], v35, s[10:11]
  global_load_dwordx2 v[26:27], v35, s[12:13]
  buffer_load_dwordx4 v[56:59], v2, s[24:27], s56 offen offset:2048 nt
  v_mfma_f32_32x32x16_bf16 v[192:207], v[80:83], v[12:15], 0
  s_nop 3
  v_cndmask_b32 v4, v96, v97, s[48:49]
  v_cndmask_b32 v5, v98, v99, s[48:49]
  v_cndmask_b32 v40, v4, v5, s[50:51]
  v_cndmask_b32 v4, v100, v101, s[48:49]
  v_cndmask_b32 v5, v102, v103, s[48:49]
  v_cndmask_b32 v41, v4, v5, s[50:51]
  v_cndmask_b32 v4, v104, v105, s[48:49]
  v_cndmask_b32 v5, v106, v107, s[48:49]
  v_cndmask_b32 v42, v4, v5, s[50:51]
  v_cndmask_b32 v4, v108, v109, s[48:49]
  v_cndmask_b32 v5, v110, v111, s[48:49]
  v_cndmask_b32 v43, v4, v5, s[50:51]
  s_waitcnt vmcnt(8)
  buffer_load_dwordx4 v[60:63], v2, s[24:27], s56 offen offset:2176 nt
  v_mfma_f32_32x32x16_bf16 v[192:207], v[84:87], v[16:19], v[192:207]
  v_cndmask_b32 v4, v112, v113, s[48:49]
  v_cndmask_b32 v5, v114, v115, s[48:49]
  v_cndmask_b32 v44, v4, v5, s[50:51]
  v_cndmask_b32 v4, v116, v117, s[48:49]
  v_cndmask_b32 v5, v118, v119, s[48:49]
  v_cndmask_b32 v45, v4, v5, s[50:51]
  v_cndmask_b32 v4, v120, v121, s[48:49]
  v_cndmask_b32 v5, v122, v123, s[48:49]
  v_cndmask_b32 v46, v4, v5, s[50:51]
  v_cndmask_b32 v4, v124, v125, s[48:49]
  v_cndmask_b32 v5, v126, v127, s[48:49]
  v_cndmask_b32 v47, v4, v5, s[50:51]
  s_waitcnt vmcnt(8)
  s_xor_b32 s56, s32, 0x9c000
  buffer_load_dwordx4 v[64:67], v2, s[24:27], s56 offen offset:0 nt
  v_mfma_f32_32x32x16_bf16 v[208:223], v[88:91], v[12:15], 0
  v_permlane16_swap_b32 v40, v44
  v_permlane16_swap_b32 v41, v45
  v_permlane16_swap_b32 v42, v46
  v_permlane16_swap_b32 v43, v47
  s_nop 0
  v_add_f32 v40, v40, v44
  v_add_f32 v41, v41, v45
  v_add_f32 v42, v42, v46
  v_add_f32 v43, v43, v47
  s_waitcnt vmcnt(8)
  buffer_load_dwordx4 v[68:71], v2, s[24:27], s56 offen offset:128 nt
  v_mfma_f32_32x32x16_bf16 v[208:223], v[92:95], v[16:19], v[208:223]
  v_add_f32_dpp v144, v40, v40 row_ror:8 row_mask:0xf bank_mask:0xf
  v_add_f32_dpp v145, v41, v41 row_ror:8 row_mask:0xf bank_mask:0xf
  v_add_f32_dpp v146, v42, v42 row_ror:8 row_mask:0xf bank_mask:0xf
  v_add_f32_dpp v147, v43, v43 row_ror:8 row_mask:0xf bank_mask:0xf
  v_max3_f32 v30, v30, v144, v145
  v_max3_f32 v30, v30, v146, v147
  s_waitcnt vmcnt(8)
  buffer_load_dwordx4 v[72:75], v2, s[24:27], s56 offen offset:2048 nt
  v_mfma_f32_32x32x16_bf16 v[96:111], v[48:51], v[12:15], 0
  s_nop 3
  v_cndmask_b32 v4, v192, v193, s[48:49]
  v_cndmask_b32 v5, v194, v195, s[48:49]
  v_cndmask_b32 v40, v4, v5, s[50:51]
  v_cndmask_b32 v4, v196, v197, s[48:49]
  v_cndmask_b32 v5, v198, v199, s[48:49]
  v_cndmask_b32 v41, v4, v5, s[50:51]
  v_cndmask_b32 v4, v200, v201, s[48:49]
  v_cndmask_b32 v5, v202, v203, s[48:49]
  v_cndmask_b32 v42, v4, v5, s[50:51]
  v_cndmask_b32 v4, v204, v205, s[48:49]
  v_cndmask_b32 v5, v206, v207, s[48:49]
  v_cndmask_b32 v43, v4, v5, s[50:51]
  s_waitcnt vmcnt(8)
  buffer_load_dwordx4 v[76:79], v2, s[24:27], s56 offen offset:2176 nt
  v_mfma_f32_32x32x16_bf16 v[96:111], v[52:55], v[16:19], v[96:111]
  v_cndmask_b32 v4, v208, v209, s[48:49]
  v_cndmask_b32 v5, v210, v211, s[48:49]
  v_cndmask_b32 v44, v4, v5, s[50:51]
  v_cndmask_b32 v4, v212, v213, s[48:49]
  v_cndmask_b32 v5, v214, v215, s[48:49]
  v_cndmask_b32 v45, v4, v5, s[50:51]
  v_cndmask_b32 v4, v216, v217, s[48:49]
  v_cndmask_b32 v5, v218, v219, s[48:49]
  v_cndmask_b32 v46, v4, v5, s[50:51]
  v_cndmask_b32 v4, v220, v221, s[48:49]
  v_cndmask_b32 v5, v222, v223, s[48:49]
  v_cndmask_b32 v47, v4, v5, s[50:51]
  s_waitcnt vmcnt(5)
  s_xor_b32 s56, s32, 0x20000
  buffer_load_dwordx4 v[80:83], v2, s[24:27], s56 offen offset:0 nt
  v_mfma_f32_32x32x16_bf16 v[112:127], v[56:59], v[12:15], 0
  v_permlane16_swap_b32 v40, v44
  v_permlane16_swap_b32 v41, v45
  v_permlane16_swap_b32 v42, v46
  v_permlane16_swap_b32 v43, v47
  s_nop 0
  v_add_f32 v40, v40, v44
  v_add_f32 v41, v41, v45
  v_add_f32 v42, v42, v46
  v_add_f32 v43, v43, v47
  s_waitcnt vmcnt(5)
  buffer_load_dwordx4 v[84:87], v2, s[24:27], s56 offen offset:128 nt
  v_mfma_f32_32x32x16_bf16 v[112:127], v[60:63], v[16:19], v[112:127]
  v_add_f32_dpp v148, v40, v40 row_ror:8 row_mask:0xf bank_mask:0xf
  v_add_f32_dpp v149, v41, v41 row_ror:8 row_mask:0xf bank_mask:0xf
  v_add_f32_dpp v150, v42, v42 row_ror:8 row_mask:0xf bank_mask:0xf
  v_add_f32_dpp v151, v43, v43 row_ror:8 row_mask:0xf bank_mask:0xf
  v_max3_f32 v30, v30, v148, v149
  v_max3_f32 v30, v30, v150, v151
  s_waitcnt vmcnt(5)
  buffer_load_dwordx4 v[88:91], v2, s[24:27], s56 offen offset:2048 nt
  v_mfma_f32_32x32x16_bf16 v[192:207], v[64:67], v[12:15], 0
  s_nop 3
  v_cndmask_b32 v4, v96, v97, s[48:49]
  v_cndmask_b32 v5, v98, v99, s[48:49]
  v_cndmask_b32 v40, v4, v5, s[50:51]
  v_cndmask_b32 v4, v100, v101, s[48:49]
  v_cndmask_b32 v5, v102, v103, s[48:49]
  v_cndmask_b32 v41, v4, v5, s[50:51]
  v_cndmask_b32 v4, v104, v105, s[48:49]
  v_cndmask_b32 v5, v106, v107, s[48:49]
  v_cndmask_b32 v42, v4, v5, s[50:51]
  v_cndmask_b32 v4, v108, v109, s[48:49]
  v_cndmask_b32 v5, v110, v111, s[48:49]
  v_cndmask_b32 v43, v4, v5, s[50:51]
  s_waitcnt vmcnt(5)
  buffer_load_dwordx4 v[92:95], v2, s[24:27], s56 offen offset:2176 nt
  v_mfma_f32_32x32x16_bf16 v[192:207], v[68:71], v[16:19], v[192:207]
  v_cndmask_b32 v4, v112, v113, s[48:49]
  v_cndmask_b32 v5, v114, v115, s[48:49]
  v_cndmask_b32 v44, v4, v5, s[50:51]
  v_cndmask_b32 v4, v116, v117, s[48:49]
  v_cndmask_b32 v5, v118, v119, s[48:49]
  v_cndmask_b32 v45, v4, v5, s[50:51]
  v_cndmask_b32 v4, v120, v121, s[48:49]
  v_cndmask_b32 v5, v122, v123, s[48:49]
  v_cndmask_b32 v46, v4, v5, s[50:51]
  v_cndmask_b32 v4, v124, v125, s[48:49]
  v_cndmask_b32 v5, v126, v127, s[48:49]
  v_cndmask_b32 v47, v4, v5, s[50:51]
  s_waitcnt vmcnt(5)
  s_xor_b32 s56, s32, 0x38000
  buffer_load_dwordx4 v[48:51], v2, s[24:27], s56 offen offset:0 nt
  s_waitcnt lgkmcnt(0)
  v_mfma_f32_32x32x16_bf16 v[208:223], v[72:75], v[12:15], 0
  v_permlane16_swap_b32 v40, v44
  v_permlane16_swap_b32 v41, v45
  v_permlane16_swap_b32 v42, v46
  v_permlane16_swap_b32 v43, v47
  s_nop 0
  v_add_f32 v40, v40, v44
  v_add_f32 v41, v41, v45
  v_add_f32 v42, v42, v46
  v_add_f32 v43, v43, v47
  s_waitcnt vmcnt(5)
  buffer_load_dwordx4 v[52:55], v2, s[24:27], s56 offen offset:128 nt
  v_mfma_f32_32x32x16_bf16 v[208:223], v[76:79], v[16:19], v[208:223]
  v_add_f32_dpp v152, v40, v40 row_ror:8 row_mask:0xf bank_mask:0xf
  v_add_f32_dpp v153, v41, v41 row_ror:8 row_mask:0xf bank_mask:0xf
  v_add_f32_dpp v154, v42, v42 row_ror:8 row_mask:0xf bank_mask:0xf
  v_add_f32_dpp v155, v43, v43 row_ror:8 row_mask:0xf bank_mask:0xf
  v_max3_f32 v30, v30, v152, v153
  v_max3_f32 v30, v30, v154, v155
  s_waitcnt vmcnt(5)
  buffer_load_dwordx4 v[56:59], v2, s[24:27], s56 offen offset:2048 nt
  v_mfma_f32_32x32x16_bf16 v[96:111], v[80:83], v[12:15], 0
  s_nop 3
  v_cndmask_b32 v4, v192, v193, s[48:49]
  v_cndmask_b32 v5, v194, v195, s[48:49]
  v_cndmask_b32 v40, v4, v5, s[50:51]
  v_cndmask_b32 v4, v196, v197, s[48:49]
  v_cndmask_b32 v5, v198, v199, s[48:49]
  v_cndmask_b32 v41, v4, v5, s[50:51]
  v_cndmask_b32 v4, v200, v201, s[48:49]
  v_cndmask_b32 v5, v202, v203, s[48:49]
  v_cndmask_b32 v42, v4, v5, s[50:51]
  v_cndmask_b32 v4, v204, v205, s[48:49]
  v_cndmask_b32 v5, v206, v207, s[48:49]
  v_cndmask_b32 v43, v4, v5, s[50:51]
  s_waitcnt vmcnt(5)
  buffer_load_dwordx4 v[60:63], v2, s[24:27], s56 offen offset:2176 nt
  v_mfma_f32_32x32x16_bf16 v[96:111], v[84:87], v[16:19], v[96:111]
  v_cndmask_b32 v4, v208, v209, s[48:49]
  v_cndmask_b32 v5, v210, v211, s[48:49]
  v_cndmask_b32 v44, v4, v5, s[50:51]
  v_cndmask_b32 v4, v212, v213, s[48:49]
  v_cndmask_b32 v5, v214, v215, s[48:49]
  v_cndmask_b32 v45, v4, v5, s[50:51]
  v_cndmask_b32 v4, v216, v217, s[48:49]
  v_cndmask_b32 v5, v218, v219, s[48:49]
  v_cndmask_b32 v46, v4, v5, s[50:51]
  v_cndmask_b32 v4, v220, v221, s[48:49]
  v_cndmask_b32 v5, v222, v223, s[48:49]
  v_cndmask_b32 v47, v4, v5, s[50:51]
  s_waitcnt vmcnt(5)
  s_xor_b32 s56, s32, 0x28000
  buffer_load_dwordx4 v[64:67], v2, s[24:27], s56 offen offset:0 nt
  v_lshlrev_b32 v4, 16, v20
  v_lshlrev_b32 v5, 16, v22
  v_mul_f32 v28, v4, v5
  v_and_b32 v4, 0xffff0000, v20
  v_and_b32 v5, 0xffff0000, v22
  v_fmac_f32 v28, v4, v5
  v_lshlrev_b32 v4, 16, v21
  v_lshlrev_b32 v5, 16, v23
  v_fmac_f32 v28, v4, v5
  v_and_b32 v4, 0xffff0000, v21
  v_and_b32 v5, 0xffff0000, v23
  v_fmac_f32 v28, v4, v5
  s_nop 1
  v_add_f32_dpp v28, v28, v28 row_ror:8 row_mask:0xf bank_mask:0xf
  s_nop 1
  v_add_f32_dpp v28, v28, v28 row_ror:4 row_mask:0xf bank_mask:0xf
  s_nop 1
  v_add_f32_dpp v28, v28, v28 row_ror:2 row_mask:0xf bank_mask:0xf
  s_nop 1
  v_add_f32_dpp v28, v28, v28 row_ror:1 row_mask:0xf bank_mask:0xf
  v_mov_b32 v4, v28
  s_nop 1
  v_permlane16_swap_b32 v28, v4
  s_nop 0
  v_add_f32 v28, v28, v4
  s_lshl_b32 s55, s33, 16
  s_and_b32 s33, s33, 0xffff0000
  s_bitcmp1_b32 s54, 0
  s_cselect_b32 s33, s33, s55
  v_sub_f32 v4, 1.0, s33
  v_mul_f32 v4, 0xceabfb8f, v4
  v_fma_f32 v28, v28, s62, v4
  v_lshlrev_b32 v24, 16, v26
  v_and_b32 v25, 0xffff0000, v26
  v_lshlrev_b32 v26, 16, v27
  v_and_b32 v27, 0xffff0000, v27
  v_mfma_f32_32x32x16_bf16 v[112:127], v[88:91], v[12:15], 0
  v_permlane16_swap_b32 v40, v44
  v_permlane16_swap_b32 v41, v45
  v_permlane16_swap_b32 v42, v46
  v_permlane16_swap_b32 v43, v47
  s_nop 0
  v_add_f32 v40, v40, v44
  v_add_f32 v41, v41, v45
  v_add_f32 v42, v42, v46
  v_add_f32 v43, v43, v47
  s_waitcnt vmcnt(5)
  buffer_load_dwordx4 v[68:71], v2, s[24:27], s56 offen offset:128 nt
  v_mfma_f32_32x32x16_bf16 v[112:127], v[92:95], v[16:19], v[112:127]
  v_add_f32_dpp v156, v40, v40 row_ror:8 row_mask:0xf bank_mask:0xf
  v_add_f32_dpp v157, v41, v41 row_ror:8 row_mask:0xf bank_mask:0xf
  v_add_f32_dpp v158, v42, v42 row_ror:8 row_mask:0xf bank_mask:0xf
  v_add_f32_dpp v159, v43, v43 row_ror:8 row_mask:0xf bank_mask:0xf
  v_max3_f32 v30, v30, v156, v157
  v_max3_f32 v30, v30, v158, v159
  s_waitcnt vmcnt(5)
  buffer_load_dwordx4 v[72:75], v2, s[24:27], s56 offen offset:2048 nt
  v_mfma_f32_32x32x16_bf16 v[192:207], v[48:51], v[12:15], 0
  s_nop 3
  v_cndmask_b32 v4, v96, v97, s[48:49]
  v_cndmask_b32 v5, v98, v99, s[48:49]
  v_cndmask_b32 v40, v4, v5, s[50:51]
  v_cndmask_b32 v4, v100, v101, s[48:49]
  v_cndmask_b32 v5, v102, v103, s[48:49]
  v_cndmask_b32 v41, v4, v5, s[50:51]
  v_cndmask_b32 v4, v104, v105, s[48:49]
  v_cndmask_b32 v5, v106, v107, s[48:49]
  v_cndmask_b32 v42, v4, v5, s[50:51]
  v_cndmask_b32 v4, v108, v109, s[48:49]
  v_cndmask_b32 v5, v110, v111, s[48:49]
  v_cndmask_b32 v43, v4, v5, s[50:51]
  s_waitcnt vmcnt(5)
  buffer_load_dwordx4 v[76:79], v2, s[24:27], s56 offen offset:2176 nt
  v_mfma_f32_32x32x16_bf16 v[192:207], v[52:55], v[16:19], v[192:207]
  v_cndmask_b32 v4, v112, v113, s[48:49]
  v_cndmask_b32 v5, v114, v115, s[48:49]
  v_cndmask_b32 v44, v4, v5, s[50:51]
  v_cndmask_b32 v4, v116, v117, s[48:49]
  v_cndmask_b32 v5, v118, v119, s[48:49]
  v_cndmask_b32 v45, v4, v5, s[50:51]
  v_cndmask_b32 v4, v120, v121, s[48:49]
  v_cndmask_b32 v5, v122, v123, s[48:49]
  v_cndmask_b32 v46, v4, v5, s[50:51]
  v_cndmask_b32 v4, v124, v125, s[48:49]
  v_cndmask_b32 v5, v126, v127, s[48:49]
  v_cndmask_b32 v47, v4, v5, s[50:51]
  s_waitcnt vmcnt(5)
  s_xor_b32 s56, s32, 0x30000
  buffer_load_dwordx4 v[80:83], v2, s[24:27], s56 offen offset:0 nt
  v_mfma_f32_32x32x16_bf16 v[208:223], v[56:59], v[12:15], 0
  v_permlane16_swap_b32 v40, v44
  v_permlane16_swap_b32 v41, v45
  v_permlane16_swap_b32 v42, v46
  v_permlane16_swap_b32 v43, v47
  s_nop 0
  v_add_f32 v40, v40, v44
  v_add_f32 v41, v41, v45
  v_add_f32 v42, v42, v46
  v_add_f32 v43, v43, v47
  s_waitcnt vmcnt(5)
  buffer_load_dwordx4 v[84:87], v2, s[24:27], s56 offen offset:128 nt
  v_mfma_f32_32x32x16_bf16 v[208:223], v[60:63], v[16:19], v[208:223]
  v_add_f32_dpp v160, v40, v40 row_ror:8 row_mask:0xf bank_mask:0xf
  v_add_f32_dpp v161, v41, v41 row_ror:8 row_mask:0xf bank_mask:0xf
  v_add_f32_dpp v162, v42, v42 row_ror:8 row_mask:0xf bank_mask:0xf
  v_add_f32_dpp v163, v43, v43 row_ror:8 row_mask:0xf bank_mask:0xf
  v_max3_f32 v30, v30, v160, v161
  v_max3_f32 v30, v30, v162, v163
  s_waitcnt vmcnt(5)
  buffer_load_dwordx4 v[88:91], v2, s[24:27], s56 offen offset:2048 nt
  global_load_dword v29, v39, s[18:19] sc1
  v_mfma_f32_32x32x16_bf16 v[96:111], v[64:67], v[12:15], 0
  s_nop 3
  v_cndmask_b32 v4, v192, v193, s[48:49]
  v_cndmask_b32 v5, v194, v195, s[48:49]
  v_cndmask_b32 v40, v4, v5, s[50:51]
  v_cndmask_b32 v4, v196, v197, s[48:49]
  v_cndmask_b32 v5, v198, v199, s[48:49]
  v_cndmask_b32 v41, v4, v5, s[50:51]
  v_cndmask_b32 v4, v200, v201, s[48:49]
  v_cndmask_b32 v5, v202, v203, s[48:49]
  v_cndmask_b32 v42, v4, v5, s[50:51]
  v_cndmask_b32 v4, v204, v205, s[48:49]
  v_cndmask_b32 v5, v206, v207, s[48:49]
  v_cndmask_b32 v43, v4, v5, s[50:51]
  s_waitcnt vmcnt(6)
  buffer_load_dwordx4 v[92:95], v2, s[24:27], s56 offen offset:2176 nt
  v_mfma_f32_32x32x16_bf16 v[96:111], v[68:71], v[16:19], v[96:111]
  v_cndmask_b32 v4, v208, v209, s[48:49]
  v_cndmask_b32 v5, v210, v211, s[48:49]
  v_cndmask_b32 v44, v4, v5, s[50:51]
  v_cndmask_b32 v4, v212, v213, s[48:49]
  v_cndmask_b32 v5, v214, v215, s[48:49]
  v_cndmask_b32 v45, v4, v5, s[50:51]
  v_cndmask_b32 v4, v216, v217, s[48:49]
  v_cndmask_b32 v5, v218, v219, s[48:49]
  v_cndmask_b32 v46, v4, v5, s[50:51]
  v_cndmask_b32 v4, v220, v221, s[48:49]
  v_cndmask_b32 v5, v222, v223, s[48:49]
  v_cndmask_b32 v47, v4, v5, s[50:51]
  s_waitcnt vmcnt(6)
  s_xor_b32 s56, s32, 0xac000
  buffer_load_dwordx4 v[48:51], v2, s[24:27], s56 offen offset:0 nt
  v_mfma_f32_32x32x16_bf16 v[112:127], v[72:75], v[12:15], 0
  v_permlane16_swap_b32 v40, v44
  v_permlane16_swap_b32 v41, v45
  v_permlane16_swap_b32 v42, v46
  v_permlane16_swap_b32 v43, v47
  s_nop 0
  v_add_f32 v40, v40, v44
  v_add_f32 v41, v41, v45
  v_add_f32 v42, v42, v46
  v_add_f32 v43, v43, v47
  s_waitcnt vmcnt(6)
  buffer_load_dwordx4 v[52:55], v2, s[24:27], s56 offen offset:128 nt
  v_mfma_f32_32x32x16_bf16 v[112:127], v[76:79], v[16:19], v[112:127]
  v_add_f32_dpp v164, v40, v40 row_ror:8 row_mask:0xf bank_mask:0xf
  v_add_f32_dpp v165, v41, v41 row_ror:8 row_mask:0xf bank_mask:0xf
  v_add_f32_dpp v166, v42, v42 row_ror:8 row_mask:0xf bank_mask:0xf
  v_add_f32_dpp v167, v43, v43 row_ror:8 row_mask:0xf bank_mask:0xf
  v_max3_f32 v30, v30, v164, v165
  v_max3_f32 v30, v30, v166, v167
  s_waitcnt vmcnt(6)
  buffer_load_dwordx4 v[56:59], v2, s[24:27], s56 offen offset:2048 nt
  v_mfma_f32_32x32x16_bf16 v[192:207], v[80:83], v[12:15], 0
  s_nop 3
  v_cndmask_b32 v4, v96, v97, s[48:49]
  v_cndmask_b32 v5, v98, v99, s[48:49]
  v_cndmask_b32 v40, v4, v5, s[50:51]
  v_cndmask_b32 v4, v100, v101, s[48:49]
  v_cndmask_b32 v5, v102, v103, s[48:49]
  v_cndmask_b32 v41, v4, v5, s[50:51]
  v_cndmask_b32 v4, v104, v105, s[48:49]
  v_cndmask_b32 v5, v106, v107, s[48:49]
  v_cndmask_b32 v42, v4, v5, s[50:51]
  v_cndmask_b32 v4, v108, v109, s[48:49]
  v_cndmask_b32 v5, v110, v111, s[48:49]
  v_cndmask_b32 v43, v4, v5, s[50:51]
  s_waitcnt vmcnt(6)
  buffer_load_dwordx4 v[60:63], v2, s[24:27], s56 offen offset:2176 nt
  v_mfma_f32_32x32x16_bf16 v[192:207], v[84:87], v[16:19], v[192:207]
  v_cndmask_b32 v4, v112, v113, s[48:49]
  v_cndmask_b32 v5, v114, v115, s[48:49]
  v_cndmask_b32 v44, v4, v5, s[50:51]
  v_cndmask_b32 v4, v116, v117, s[48:49]
  v_cndmask_b32 v5, v118, v119, s[48:49]
  v_cndmask_b32 v45, v4, v5, s[50:51]
  v_cndmask_b32 v4, v120, v121, s[48:49]
  v_cndmask_b32 v5, v122, v123, s[48:49]
  v_cndmask_b32 v46, v4, v5, s[50:51]
  v_cndmask_b32 v4, v124, v125, s[48:49]
  v_cndmask_b32 v5, v126, v127, s[48:49]
  v_cndmask_b32 v47, v4, v5, s[50:51]
  s_waitcnt vmcnt(6)
  s_xor_b32 s56, s32, 0xb4000
  buffer_load_dwordx4 v[64:67], v2, s[24:27], s56 offen offset:0 nt
  v_mfma_f32_32x32x16_bf16 v[208:223], v[88:91], v[12:15], 0
  v_permlane16_swap_b32 v40, v44
  v_permlane16_swap_b32 v41, v45
  v_permlane16_swap_b32 v42, v46
  v_permlane16_swap_b32 v43, v47
  s_nop 0
  v_add_f32 v40, v40, v44
  v_add_f32 v41, v41, v45
  v_add_f32 v42, v42, v46
  v_add_f32 v43, v43, v47
  s_waitcnt vmcnt(5)
  buffer_load_dwordx4 v[68:71], v2, s[24:27], s56 offen offset:128 nt
  s_mov_b32 s69, 0
L_flag:
  v_readfirstlane_b32 s63, v29
  s_nop 1
  s_cmp_lg_u32 s63, 0
  s_cbranch_scc1 L_flag_ok
  s_add_u32 s69, s69, 1
  s_cmp_ge_u32 s69, 0x80000
  s_cbranch_scc1 L_end
  global_load_dword v29, v39, s[18:19] sc1
  s_waitcnt vmcnt(0)
  s_branch L_flag
L_flag_ok:
  s_bfe_u32 s35, s63, 0x80008
  v_and_b32 v29, 0xff, v29
  v_and_b32 v4, 3, v1
  v_lshrrev_b32 v5, 5, v1
  v_lshlrev_b32 v4, 4, v4
  v_lshl_add_u32 v39, v5, 6, v4
  s_lshl_b32 s42, s63, 8
  s_cmp_lg_u32 s23, 0
  s_cbranch_scc1 L_noinit
  s_mov_b32 s41, s42
  s_atomic_swap s41, s[20:21], s43
L_noinit:
  v_mfma_f32_32x32x16_bf16 v[208:223], v[92:95], v[16:19], v[208:223]
  v_add_f32_dpp v168, v40, v40 row_ror:8 row_mask:0xf bank_mask:0xf
  v_add_f32_dpp v169, v41, v41 row_ror:8 row_mask:0xf bank_mask:0xf
  v_add_f32_dpp v170, v42, v42 row_ror:8 row_mask:0xf bank_mask:0xf
  v_add_f32_dpp v171, v43, v43 row_ror:8 row_mask:0xf bank_mask:0xf
  v_max3_f32 v30, v30, v168, v169
  v_max3_f32 v30, v30, v170, v171
  s_waitcnt vmcnt(5)
  buffer_load_dwordx4 v[72:75], v2, s[24:27], s56 offen offset:2048 nt
  v_mfma_f32_32x32x16_bf16 v[96:111], v[48:51], v[12:15], 0
  s_nop 3
  v_cndmask_b32 v4, v192, v193, s[48:49]
  v_cndmask_b32 v5, v194, v195, s[48:49]
  v_cndmask_b32 v40, v4, v5, s[50:51]
  v_cndmask_b32 v4, v196, v197, s[48:49]
  v_cndmask_b32 v5, v198, v199, s[48:49]
  v_cndmask_b32 v41, v4, v5, s[50:51]
  v_cndmask_b32 v4, v200, v201, s[48:49]
  v_cndmask_b32 v5, v202, v203, s[48:49]
  v_cndmask_b32 v42, v4, v5, s[50:51]
  v_cndmask_b32 v4, v204, v205, s[48:49]
  v_cndmask_b32 v5, v206, v207, s[48:49]
  v_cndmask_b32 v43, v4, v5, s[50:51]
  s_waitcnt vmcnt(5)
  buffer_load_dwordx4 v[76:79], v2, s[24:27], s56 offen offset:2176 nt
  v_mfma_f32_32x32x16_bf16 v[96:111], v[52:55], v[16:19], v[96:111]
  v_cndmask_b32 v4, v208, v209, s[48:49]
  v_cndmask_b32 v5, v210, v211, s[48:49]
  v_cndmask_b32 v44, v4, v5, s[50:51]
  v_cndmask_b32 v4, v212, v213, s[48:49]
  v_cndmask_b32 v5, v214, v215, s[48:49]
  v_cndmask_b32 v45, v4, v5, s[50:51]
  v_cndmask_b32 v4, v216, v217, s[48:49]
  v_cndmask_b32 v5, v218, v219, s[48:49]
  v_cndmask_b32 v46, v4, v5, s[50:51]
  v_cndmask_b32 v4, v220, v221, s[48:49]
  v_cndmask_b32 v5, v222, v223, s[48:49]
  v_cndmask_b32 v47, v4, v5, s[50:51]
  s_waitcnt vmcnt(5)
  s_xor_b32 s56, s32, 0xa4000
  buffer_load_dwordx4 v[80:83], v2, s[24:27], s56 offen offset:0 nt
  v_mfma_f32_32x32x16_bf16 v[112:127], v[56:59], v[12:15], 0
  v_permlane16_swap_b32 v40, v44
  v_permlane16_swap_b32 v41, v45
  v_permlane16_swap_b32 v42, v46
  v_permlane16_swap_b32 v43, v47
  s_nop 0
  v_add_f32 v40, v40, v44
  v_add_f32 v41, v41, v45
  v_add_f32 v42, v42, v46
  v_add_f32 v43, v43, v47
  s_waitcnt vmcnt(5)
  buffer_load_dwordx4 v[84:87], v2, s[24:27], s56 offen offset:128 nt
  v_mfma_f32_32x32x16_bf16 v[112:127], v[60:63], v[16:19], v[112:127]
  v_add_f32_dpp v172, v40, v40 row_ror:8 row_mask:0xf bank_mask:0xf
  v_add_f32_dpp v173, v41, v41 row_ror:8 row_mask:0xf bank_mask:0xf
  v_add_f32_dpp v174, v42, v42 row_ror:8 row_mask:0xf bank_mask:0xf
  v_add_f32_dpp v175, v43, v43 row_ror:8 row_mask:0xf bank_mask:0xf
  v_max3_f32 v30, v30, v172, v173
  v_max3_f32 v30, v30, v174, v175
  s_waitcnt vmcnt(5)
  buffer_load_dwordx4 v[88:91], v2, s[24:27], s56 offen offset:2048 nt
  v_mfma_f32_32x32x16_bf16 v[192:207], v[64:67], v[12:15], 0
  s_nop 3
  v_cndmask_b32 v4, v96, v97, s[48:49]
  v_cndmask_b32 v5, v98, v99, s[48:49]
  v_cndmask_b32 v40, v4, v5, s[50:51]
  v_cndmask_b32 v4, v100, v101, s[48:49]
  v_cndmask_b32 v5, v102, v103, s[48:49]
  v_cndmask_b32 v41, v4, v5, s[50:51]
  v_cndmask_b32 v4, v104, v105, s[48:49]
  v_cndmask_b32 v5, v106, v107, s[48:49]
  v_cndmask_b32 v42, v4, v5, s[50:51]
  v_cndmask_b32 v4, v108, v109, s[48:49]
  v_cndmask_b32 v5, v110, v111, s[48:49]
  v_cndmask_b32 v43, v4, v5, s[50:51]
  s_waitcnt vmcnt(5)
  buffer_load_dwordx4 v[92:95], v2, s[24:27], s56 offen offset:2176 nt
  v_mfma_f32_32x32x16_bf16 v[192:207], v[68:71], v[16:19], v[192:207]
  v_cndmask_b32 v4, v112, v113, s[48:49]
  v_cndmask_b32 v5, v114, v115, s[48:49]
  v_cndmask_b32 v44, v4, v5, s[50:51]
  v_cndmask_b32 v4, v116, v117, s[48:49]
  v_cndmask_b32 v5, v118, v119, s[48:49]
  v_cndmask_b32 v45, v4, v5, s[50:51]
  v_cndmask_b32 v4, v120, v121, s[48:49]
  v_cndmask_b32 v5, v122, v123, s[48:49]
  v_cndmask_b32 v46, v4, v5, s[50:51]
  v_cndmask_b32 v4, v124, v125, s[48:49]
  v_cndmask_b32 v5, v126, v127, s[48:49]
  v_cndmask_b32 v47, v4, v5, s[50:51]
  s_waitcnt vmcnt(5)
  s_xor_b32 s56, s32, 0xbc000
  buffer_load_dwordx4 v[48:51], v2, s[24:27], s56 offen offset:0 nt
  v_mfma_f32_32x32x16_bf16 v[208:223], v[72:75], v[12:15], 0
  v_permlane16_swap_b32 v40, v44
  v_permlane16_swap_b32 v41, v45
  v_permlane16_swap_b32 v42, v46
  v_permlane16_swap_b32 v43, v47
  s_nop 0
  v_add_f32 v40, v40, v44
  v_add_f32 v41, v41, v45
  v_add_f32 v42, v42, v46
  v_add_f32 v43, v43, v47
  s_waitcnt vmcnt(5)
  buffer_load_dwordx4 v[52:55], v2, s[24:27], s56 offen offset:128 nt
  v_mfma_f32_32x32x16_bf16 v[208:223], v[76:79], v[16:19], v[208:223]
  v_add_f32_dpp v176, v40, v40 row_ror:8 row_mask:0xf bank_mask:0xf
  v_add_f32_dpp v177, v41, v41 row_ror:8 row_mask:0xf bank_mask:0xf
  v_add_f32_dpp v178, v42, v42 row_ror:8 row_mask:0xf bank_mask:0xf
  v_add_f32_dpp v179, v43, v43 row_ror:8 row_mask:0xf bank_mask:0xf
  v_max3_f32 v30, v30, v176, v177
  v_max3_f32 v30, v30, v178, v179
  s_waitcnt vmcnt(5)
  buffer_load_dwordx4 v[56:59], v2, s[24:27], s56 offen offset:2048 nt
  v_mfma_f32_32x32x16_bf16 v[96:111], v[80:83], v[12:15], 0
  s_nop 3
  v_cndmask_b32 v4, v192, v193, s[48:49]
  v_cndmask_b32 v5, v194, v195, s[48:49]
  v_cndmask_b32 v40, v4, v5, s[50:51]
  v_cndmask_b32 v4, v196, v197, s[48:49]
  v_cndmask_b32 v5, v198, v199, s[48:49]
  v_cndmask_b32 v41, v4, v5, s[50:51]
  v_cndmask_b32 v4, v200, v201, s[48:49]
  v_cndmask_b32 v5, v202, v203, s[48:49]
  v_cndmask_b32 v42, v4, v5, s[50:51]
  v_cndmask_b32 v4, v204, v205, s[48:49]
  v_cndmask_b32 v5, v206, v207, s[48:49]
  v_cndmask_b32 v43, v4, v5, s[50:51]
  s_waitcnt vmcnt(5)
  buffer_load_dwordx4 v[60:63], v2, s[24:27], s56 offen offset:2176 nt
  v_mfma_f32_32x32x16_bf16 v[96:111], v[84:87], v[16:19], v[96:111]
  v_cndmask_b32 v4, v208, v209, s[48:49]
  v_cndmask_b32 v5, v210, v211, s[48:49]
  v_cndmask_b32 v44, v4, v5, s[50:51]
  v_cndmask_b32 v4, v212, v213, s[48:49]
  v_cndmask_b32 v5, v214, v215, s[48:49]
  v_cndmask_b32 v45, v4, v5, s[50:51]
  v_cndmask_b32 v4, v216, v217, s[48:49]
  v_cndmask_b32 v5, v218, v219, s[48:49]
  v_cndmask_b32 v46, v4, v5, s[50:51]
  v_cndmask_b32 v4, v220, v221, s[48:49]
  v_cndmask_b32 v5, v222, v223, s[48:49]
  v_cndmask_b32 v47, v4, v5, s[50:51]
  s_waitcnt vmcnt(5)
  s_xor_b32 s57, s32, 0x0
  buffer_load_dwordx4 v[64:67], v3, s[28:31], s57 offen offset:0 nt
  v_mfma_f32_32x32x16_bf16 v[112:127], v[88:91], v[12:15], 0
  v_permlane16_swap_b32 v40, v44
  v_permlane16_swap_b32 v41, v45
  v_permlane16_swap_b32 v42, v46
  v_permlane16_swap_b32 v43, v47
  s_nop 0
  v_add_f32 v40, v40, v44
  v_add_f32 v41, v41, v45
  v_add_f32 v42, v42, v46
  v_add_f32 v43, v43, v47
  s_waitcnt vmcnt(5)
  buffer_load_dwordx4 v[68:71], v3, s[28:31], s57 offen offset:512 nt
  v_mfma_f32_32x32x16_bf16 v[112:127], v[92:95], v[16:19], v[112:127]
  v_add_f32_dpp v180, v40, v40 row_ror:8 row_mask:0xf bank_mask:0xf
  v_add_f32_dpp v181, v41, v41 row_ror:8 row_mask:0xf bank_mask:0xf
  v_add_f32_dpp v182, v42, v42 row_ror:8 row_mask:0xf bank_mask:0xf
  v_add_f32_dpp v183, v43, v43 row_ror:8 row_mask:0xf bank_mask:0xf
  v_max3_f32 v30, v30, v180, v181
  v_max3_f32 v30, v30, v182, v183
  s_waitcnt vmcnt(5)
  buffer_load_dwordx4 v[72:75], v3, s[28:31], s57 offen offset:1024 nt
  v_mfma_f32_32x32x16_bf16 v[192:207], v[48:51], v[12:15], 0
  s_nop 3
  v_cndmask_b32 v4, v96, v97, s[48:49]
  v_cndmask_b32 v5, v98, v99, s[48:49]
  v_cndmask_b32 v40, v4, v5, s[50:51]
  v_cndmask_b32 v4, v100, v101, s[48:49]
  v_cndmask_b32 v5, v102, v103, s[48:49]
  v_cndmask_b32 v41, v4, v5, s[50:51]
  v_cndmask_b32 v4, v104, v105, s[48:49]
  v_cndmask_b32 v5, v106, v107, s[48:49]
  v_cndmask_b32 v42, v4, v5, s[50:51]
  v_cndmask_b32 v4, v108, v109, s[48:49]
  v_cndmask_b32 v5, v110, v111, s[48:49]
  v_cndmask_b32 v43, v4, v5, s[50:51]
  s_waitcnt vmcnt(5)
  buffer_load_dwordx4 v[76:79], v3, s[28:31], s57 offen offset:1536 nt
  v_mfma_f32_32x32x16_bf16 v[192:207], v[52:55], v[16:19], v[192:207]
  v_cndmask_b32 v4, v112, v113, s[48:49]
  v_cndmask_b32 v5, v114, v115, s[48:49]
  v_cndmask_b32 v44, v4, v5, s[50:51]
  v_cndmask_b32 v4, v116, v117, s[48:49]
  v_cndmask_b32 v5, v118, v119, s[48:49]
  v_cndmask_b32 v45, v4, v5, s[50:51]
  v_cndmask_b32 v4, v120, v121, s[48:49]
  v_cndmask_b32 v5, v122, v123, s[48:49]
  v_cndmask_b32 v46, v4, v5, s[50:51]
  v_cndmask_b32 v4, v124, v125, s[48:49]
  v_cndmask_b32 v5, v126, v127, s[48:49]
  v_cndmask_b32 v47, v4, v5, s[50:51]
  s_waitcnt vmcnt(5)
  s_xor_b32 s57, s32, 0x18000
  buffer_load_dwordx4 v[80:83], v3, s[28:31], s57 offen offset:0 nt
  v_mfma_f32_32x32x16_bf16 v[208:223], v[56:59], v[12:15], 0
  v_permlane16_swap_b32 v40, v44
  v_permlane16_swap_b32 v41, v45
  v_permlane16_swap_b32 v42, v46
  v_permlane16_swap_b32 v43, v47
  s_nop 0
  v_add_f32 v40, v40, v44
  v_add_f32 v41, v41, v45
  v_add_f32 v42, v42, v46
  v_add_f32 v43, v43, v47
  s_waitcnt vmcnt(5)
  buffer_load_dwordx4 v[84:87], v3, s[28:31], s57 offen offset:512 nt
  v_mfma_f32_32x32x16_bf16 v[208:223], v[60:63], v[16:19], v[208:223]
  v_add_f32_dpp v184, v40, v40 row_ror:8 row_mask:0xf bank_mask:0xf
  v_add_f32_dpp v185, v41, v41 row_ror:8 row_mask:0xf bank_mask:0xf
  v_add_f32_dpp v186, v42, v42 row_ror:8 row_mask:0xf bank_mask:0xf
  v_add_f32_dpp v187, v43, v43 row_ror:8 row_mask:0xf bank_mask:0xf
  v_max3_f32 v30, v30, v184, v185
  v_max3_f32 v30, v30, v186, v187
  s_waitcnt vmcnt(5)
  buffer_load_dwordx4 v[88:91], v3, s[28:31], s57 offen offset:1024 nt
  s_nop 5
  v_cndmask_b32 v4, v192, v193, s[48:49]
  v_cndmask_b32 v5, v194, v195, s[48:49]
  v_cndmask_b32 v40, v4, v5, s[50:51]
  v_cndmask_b32 v4, v196, v197, s[48:49]
  v_cndmask_b32 v5, v198, v199, s[48:49]
  v_cndmask_b32 v41, v4, v5, s[50:51]
  v_cndmask_b32 v4, v200, v201, s[48:49]
  v_cndmask_b32 v5, v202, v203, s[48:49]
  v_cndmask_b32 v42, v4, v5, s[50:51]
  v_cndmask_b32 v4, v204, v205, s[48:49]
  v_cndmask_b32 v5, v206, v207, s[48:49]
  v_cndmask_b32 v43, v4, v5, s[50:51]
  s_waitcnt vmcnt(5)
  buffer_load_dwordx4 v[92:95], v3, s[28:31], s57 offen offset:1536 nt
  v_cndmask_b32 v4, v208, v209, s[48:49]
  v_cndmask_b32 v5, v210, v211, s[48:49]
  v_cndmask_b32 v44, v4, v5, s[50:51]
  v_cndmask_b32 v4, v212, v213, s[48:49]
  v_cndmask_b32 v5, v214, v215, s[48:49]
  v_cndmask_b32 v45, v4, v5, s[50:51]
  v_cndmask_b32 v4, v216, v217, s[48:49]
  v_cndmask_b32 v5, v218, v219, s[48:49]
  v_cndmask_b32 v46, v4, v5, s[50:51]
  v_cndmask_b32 v4, v220, v221, s[48:49]
  v_cndmask_b32 v5, v222, v223, s[48:49]
  v_cndmask_b32 v47, v4, v5, s[50:51]
  v_perm_b32 v192, v68, v64, s60
  v_perm_b32 v196, v68, v64, s61
  v_perm_b32 v200, v69, v65, s60
  v_perm_b32 v204, v69, v65, s61
  v_perm_b32 v208, v70, v66, s60
  v_perm_b32 v212, v70, v66, s61
  v_perm_b32 v216, v71, v67, s60
  v_perm_b32 v220, v71, v67, s61
  s_waitcnt vmcnt(5)
  s_xor_b32 s57, s32, 0x8000
  buffer_load_dwordx4 v[48:51], v3, s[28:31], s57 offen offset:0 nt
  v_permlane16_swap_b32 v40, v44
  v_permlane16_swap_b32 v41, v45
  v_permlane16_swap_b32 v42, v46
  v_permlane16_swap_b32 v43, v47
  s_nop 0
  v_add_f32 v40, v40, v44
  v_add_f32 v41, v41, v45
  v_add_f32 v42, v42, v46
  v_add_f32 v43, v43, v47
  s_nop 1
  v_add_f32_dpp v188, v40, v40 row_ror:8 row_mask:0xf bank_mask:0xf
  v_add_f32_dpp v189, v41, v41 row_ror:8 row_mask:0xf bank_mask:0xf
  v_add_f32_dpp v190, v42, v42 row_ror:8 row_mask:0xf bank_mask:0xf
  v_add_f32_dpp v191, v43, v43 row_ror:8 row_mask:0xf bank_mask:0xf
  v_max3_f32 v30, v30, v188, v189
  v_max3_f32 v30, v30, v190, v191
  v_mov_b32 v4, v30
  s_nop 1
  v_permlane16_swap_b32 v30, v4
  s_nop 0
  v_max_f32 v30, v30, v4
  v_mov_b32 v4, v30
  s_nop 1
  v_permlane32_swap_b32 v30, v4
  s_nop 0
  v_max_f32 v30, v30, v4
  v_add_u32 v4, s58, v0
  ds_write_b32 v4, v30
  s_waitcnt vmcnt(5)
  buffer_load_dwordx4 v[52:55], v3, s[28:31], s57 offen offset:512 nt
  s_waitcnt lgkmcnt(0)
  s_barrier
  ds_read_b128 v[44:47], v0
  ds_read_b128 v[12:15], v38
  v_perm_b32 v193, v76, v72, s60
  v_perm_b32 v197, v76, v72, s61
  v_perm_b32 v201, v77, v73, s60
  v_perm_b32 v205, v77, v73, s61
  v_perm_b32 v209, v78, v74, s60
  v_perm_b32 v213, v78, v74, s61
  v_perm_b32 v217, v79, v75, s60
  v_perm_b32 v221, v79, v75, s61
  s_waitcnt vmcnt(5)
  buffer_load_dwordx4 v[56:59], v3, s[28:31], s57 offen offset:1024 nt
  s_waitcnt lgkmcnt(0)
  v_max3_f32 v30, v44, v45, v46
  v_max3_f32 v16, v12, v13, v14
  v_max_f32 v30, v30, v47
  v_max_f32 v16, v16, v15
  v_mul_f32 v30, s62, v30
  v_mul_f32 v16, s62, v16
  v_mov_b32 v2, s35
  v_mov_b32 v17, s63
  v_mov_b32 v19, s63
  v_sub_f32 v32, 0, v30
  v_fma_f32 v4, v128, s62, v32
  v_fma_f32 v5, v129, s62, v32
  v_exp_f32 v4, v4
  v_exp_f32 v5, v5
  s_nop 0
  v_cvt_pk_bf16_f32 v8, v4, v5
  v_add_f32 v31, v31, v4
  v_add_f32 v31, v31, v5
  s_waitcnt vmcnt(5)
  buffer_load_dwordx4 v[60:63], v3, s[28:31], s57 offen offset:1536 nt
  v_fma_f32 v4, v130, s62, v32
  v_fma_f32 v5, v131, s62, v32
  v_exp_f32 v4, v4
  v_exp_f32 v5, v5
  s_nop 0
  v_cvt_pk_bf16_f32 v9, v4, v5
  v_add_f32 v31, v31, v4
  v_add_f32 v31, v31, v5
  v_perm_b32 v194, v84, v80, s60
  v_perm_b32 v198, v84, v80, s61
  v_perm_b32 v202, v85, v81, s60
  v_perm_b32 v206, v85, v81, s61
  v_perm_b32 v210, v86, v82, s60
  v_perm_b32 v214, v86, v82, s61
  v_perm_b32 v218, v87, v83, s60
  v_perm_b32 v222, v87, v83, s61
  s_waitcnt vmcnt(5)
  s_xor_b32 s57, s32, 0x10000
  buffer_load_dwordx4 v[64:67], v3, s[28:31], s57 offen offset:0 nt
  v_fma_f32 v4, v132, s62, v32
  v_fma_f32 v5, v133, s62, v32
  v_exp_f32 v4, v4
  v_exp_f32 v5, v5
  s_nop 0
  v_cvt_pk_bf16_f32 v10, v4, v5
  v_add_f32 v31, v31, v4
  v_add_f32 v31, v31, v5
  s_waitcnt vmcnt(5)
  buffer_load_dwordx4 v[68:71], v3, s[28:31], s57 offen offset:512 nt
  v_fma_f32 v4, v134, s62, v32
  v_fma_f32 v5, v135, s62, v32
  v_exp_f32 v4, v4
  v_exp_f32 v5, v5
  s_nop 0
  v_cvt_pk_bf16_f32 v11, v4, v5
  v_add_f32 v31, v31, v4
  v_add_f32 v31, v31, v5
  v_perm_b32 v195, v92, v88, s60
  v_perm_b32 v199, v92, v88, s61
  v_perm_b32 v203, v93, v89, s60
  v_perm_b32 v207, v93, v89, s61
  v_perm_b32 v211, v94, v90, s60
  v_perm_b32 v215, v94, v90, s61
  v_perm_b32 v219, v95, v91, s60
  v_perm_b32 v223, v95, v91, s61
  s_waitcnt vmcnt(5)
  buffer_load_dwordx4 v[72:75], v3, s[28:31], s57 offen offset:1024 nt
  v_mfma_f32_16x16x32_bf16 v[224:227], v[192:195], v[8:11], 0
  v_fma_f32 v4, v136, s62, v32
  v_fma_f32 v5, v137, s62, v32
  v_exp_f32 v4, v4
  v_exp_f32 v5, v5
  s_nop 0
  v_cvt_pk_bf16_f32 v40, v4, v5
  v_add_f32 v31, v31, v4
  v_add_f32 v31, v31, v5
  s_waitcnt vmcnt(5)
  buffer_load_dwordx4 v[76:79], v3, s[28:31], s57 offen offset:1536 nt
  v_mfma_f32_16x16x32_bf16 v[228:231], v[196:199], v[8:11], 0
  v_perm_b32 v96, v52, v48, s60
  v_perm_b32 v100, v52, v48, s61
  v_perm_b32 v104, v53, v49, s60
  v_perm_b32 v108, v53, v49, s61
  v_perm_b32 v112, v54, v50, s60
  v_perm_b32 v116, v54, v50, s61
  v_perm_b32 v120, v55, v51, s60
  v_perm_b32 v124, v55, v51, s61
  s_waitcnt vmcnt(5)
  s_xor_b32 s57, s32, 0x8c000
  buffer_load_dwordx4 v[80:83], v3, s[28:31], s57 offen offset:0 nt
  v_mfma_f32_16x16x32_bf16 v[232:235], v[200:203], v[8:11], 0
  v_fma_f32 v4, v138, s62, v32
  v_fma_f32 v5, v139, s62, v32
  v_exp_f32 v4, v4
  v_exp_f32 v5, v5
  s_nop 0
  v_cvt_pk_bf16_f32 v41, v4, v5
  v_add_f32 v31, v31, v4
  v_add_f32 v31, v31, v5
  s_waitcnt vmcnt(5)
  buffer_load_dwordx4 v[84:87], v3, s[28:31], s57 offen offset:512 nt
  v_mfma_f32_16x16x32_bf16 v[236:239], v[204:207], v[8:11], 0
  v_perm_b32 v97, v60, v56, s60
  v_perm_b32 v101, v60, v56, s61
  v_perm_b32 v105, v61, v57, s60
  v_perm_b32 v109, v61, v57, s61
  v_perm_b32 v113, v62, v58, s60
  v_perm_b32 v117, v62, v58, s61
  v_perm_b32 v121, v63, v59, s60
  v_perm_b32 v125, v63, v59, s61
  s_waitcnt vmcnt(5)
  buffer_load_dwordx4 v[88:91], v3, s[28:31], s57 offen offset:1024 nt
  v_mfma_f32_16x16x32_bf16 v[240:243], v[208:211], v[8:11], 0
  v_fma_f32 v4, v140, s62, v32
  v_fma_f32 v5, v141, s62, v32
  v_exp_f32 v4, v4
  v_exp_f32 v5, v5
  s_nop 0
  v_cvt_pk_bf16_f32 v42, v4, v5
  v_add_f32 v31, v31, v4
  v_add_f32 v31, v31, v5
  s_waitcnt vmcnt(5)
  buffer_load_dwordx4 v[92:95], v3, s[28:31], s57 offen offset:1536 nt
  v_mfma_f32_16x16x32_bf16 v[244:247], v[212:215], v[8:11], 0
  v_perm_b32 v98, v68, v64, s60
  v_perm_b32 v102, v68, v64, s61
  v_perm_b32 v106, v69, v65, s60
  v_perm_b32 v110, v69, v65, s61
  v_perm_b32 v114, v70, v66, s60
  v_perm_b32 v118, v70, v66, s61
  v_perm_b32 v122, v71, v67, s60
  v_perm_b32 v126, v71, v67, s61
  s_waitcnt vmcnt(5)
  s_xor_b32 s57, s32, 0x94000
  buffer_load_dwordx4 v[48:51], v3, s[28:31], s57 offen offset:0 nt
  v_mfma_f32_16x16x32_bf16 v[248:251], v[216:219], v[8:11], 0
  v_fma_f32 v4, v142, s62, v32
  v_fma_f32 v5, v143, s62, v32
  v_exp_f32 v4, v4
  v_exp_f32 v5, v5
  s_nop 0
  v_cvt_pk_bf16_f32 v43, v4, v5
  v_add_f32 v31, v31, v4
  v_add_f32 v31, v31, v5
  s_waitcnt vmcnt(5)
  buffer_load_dwordx4 v[52:55], v3, s[28:31], s57 offen offset:512 nt
  v_mfma_f32_16x16x32_bf16 v[252:255], v[220:223], v[8:11], 0
  v_perm_b32 v99, v76, v72, s60
  v_perm_b32 v103, v76, v72, s61
  v_perm_b32 v107, v77, v73, s60
  v_perm_b32 v111, v77, v73, s61
  v_perm_b32 v115, v78, v74, s60
  v_perm_b32 v119, v78, v74, s61
  v_perm_b32 v123, v79, v75, s60
  v_perm_b32 v127, v79, v75, s61
  s_waitcnt vmcnt(5)
  buffer_load_dwordx4 v[56:59], v3, s[28:31], s57 offen offset:1024 nt
  v_mfma_f32_16x16x32_bf16 v[224:227], v[96:99], v[40:43], v[224:227]
  v_fma_f32 v4, v144, s62, v32
  v_fma_f32 v5, v145, s62, v32
  v_exp_f32 v4, v4
  v_exp_f32 v5, v5
  s_nop 0
  v_cvt_pk_bf16_f32 v8, v4, v5
  v_add_f32 v31, v31, v4
  v_add_f32 v31, v31, v5
  s_waitcnt vmcnt(5)
  buffer_load_dwordx4 v[60:63], v3, s[28:31], s57 offen offset:1536 nt
  v_mfma_f32_16x16x32_bf16 v[228:231], v[100:103], v[40:43], v[228:231]
  v_perm_b32 v192, v84, v80, s60
  v_perm_b32 v196, v84, v80, s61
  v_perm_b32 v200, v85, v81, s60
  v_perm_b32 v204, v85, v81, s61
  v_perm_b32 v208, v86, v82, s60
  v_perm_b32 v212, v86, v82, s61
  v_perm_b32 v216, v87, v83, s60
  v_perm_b32 v220, v87, v83, s61
  s_waitcnt vmcnt(5)
  s_xor_b32 s57, s32, 0x84000
  buffer_load_dwordx4 v[64:67], v3, s[28:31], s57 offen offset:0 nt
  v_mfma_f32_16x16x32_bf16 v[232:235], v[104:107], v[40:43], v[232:235]
  v_fma_f32 v4, v146, s62, v32
  v_fma_f32 v5, v147, s62, v32
  v_exp_f32 v4, v4
  v_exp_f32 v5, v5
  s_nop 0
  v_cvt_pk_bf16_f32 v9, v4, v5
  v_add_f32 v31, v31, v4
  v_add_f32 v31, v31, v5
  s_waitcnt vmcnt(5)
  buffer_load_dwordx4 v[68:71], v3, s[28:31], s57 offen offset:512 nt
  v_mfma_f32_16x16x32_bf16 v[236:239], v[108:111], v[40:43], v[236:239]
  v_perm_b32 v193, v92, v88, s60
  v_perm_b32 v197, v92, v88, s61
  v_perm_b32 v201, v93, v89, s60
  v_perm_b32 v205, v93, v89, s61
  v_perm_b32 v209, v94, v90, s60
  v_perm_b32 v213, v94, v90, s61
  v_perm_b32 v217, v95, v91, s60
  v_perm_b32 v221, v95, v91, s61
  s_waitcnt vmcnt(5)
  buffer_load_dwordx4 v[72:75], v3, s[28:31], s57 offen offset:1024 nt
  v_mfma_f32_16x16x32_bf16 v[240:243], v[112:115], v[40:43], v[240:243]
  v_fma_f32 v4, v148, s62, v32
  v_fma_f32 v5, v149, s62, v32
  v_exp_f32 v4, v4
  v_exp_f32 v5, v5
  s_nop 0
  v_cvt_pk_bf16_f32 v10, v4, v5
  v_add_f32 v31, v31, v4
  v_add_f32 v31, v31, v5
  s_waitcnt vmcnt(5)
  buffer_load_dwordx4 v[76:79], v3, s[28:31], s57 offen offset:1536 nt
  v_mfma_f32_16x16x32_bf16 v[244:247], v[116:119], v[40:43], v[244:247]
  v_perm_b32 v194, v52, v48, s60
  v_perm_b32 v198, v52, v48, s61
  v_perm_b32 v202, v53, v49, s60
  v_perm_b32 v206, v53, v49, s61
  v_perm_b32 v210, v54, v50, s60
  v_perm_b32 v214, v54, v50, s61
  v_perm_b32 v218, v55, v51, s60
  v_perm_b32 v222, v55, v51, s61
  s_waitcnt vmcnt(5)
  s_xor_b32 s57, s32, 0x9c000
  buffer_load_dwordx4 v[80:83], v3, s[28:31], s57 offen offset:0 nt
  v_mfma_f32_16x16x32_bf16 v[248:251], v[120:123], v[40:43], v[248:251]
  v_fma_f32 v4, v150, s62, v32
  v_fma_f32 v5, v151, s62, v32
  v_exp_f32 v4, v4
  v_exp_f32 v5, v5
  s_nop 0
  v_cvt_pk_bf16_f32 v11, v4, v5
  v_add_f32 v31, v31, v4
  v_add_f32 v31, v31, v5
  s_waitcnt vmcnt(5)
  buffer_load_dwordx4 v[84:87], v3, s[28:31], s57 offen offset:512 nt
  v_mfma_f32_16x16x32_bf16 v[252:255], v[124:127], v[40:43], v[252:255]
  v_perm_b32 v195, v60, v56, s60
  v_perm_b32 v199, v60, v56, s61
  v_perm_b32 v203, v61, v57, s60
  v_perm_b32 v207, v61, v57, s61
  v_perm_b32 v211, v62, v58, s60
  v_perm_b32 v215, v62, v58, s61
  v_perm_b32 v219, v63, v59, s60
  v_perm_b32 v223, v63, v59, s61
  s_waitcnt vmcnt(5)
  buffer_load_dwordx4 v[88:91], v3, s[28:31], s57 offen offset:1024 nt
  v_mfma_f32_16x16x32_bf16 v[224:227], v[192:195], v[8:11], v[224:227]
  v_fma_f32 v4, v152, s62, v32
  v_fma_f32 v5, v153, s62, v32
  v_exp_f32 v4, v4
  v_exp_f32 v5, v5
  s_nop 0
  v_cvt_pk_bf16_f32 v40, v4, v5
  v_add_f32 v31, v31, v4
  v_add_f32 v31, v31, v5
  s_waitcnt vmcnt(5)
  buffer_load_dwordx4 v[92:95], v3, s[28:31], s57 offen offset:1536 nt
  v_mfma_f32_16x16x32_bf16 v[228:231], v[196:199], v[8:11], v[228:231]
  v_fma_f32 v4, v176, s62, v32
  v_fma_f32 v5, v177, s62, v32
  v_exp_f32 v4, v4
  v_exp_f32 v5, v5
  s_nop 0
  v_cvt_pk_bf16_f32 v44, v4, v5
  v_add_f32 v31, v31, v4
  v_add_f32 v31, v31, v5
  v_perm_b32 v96, v68, v64, s60
  v_perm_b32 v100, v68, v64, s61
  v_perm_b32 v104, v69, v65, s60
  v_perm_b32 v108, v69, v65, s61
  v_perm_b32 v112, v70, v66, s60
  v_perm_b32 v116, v70, v66, s61
  v_perm_b32 v120, v71, v67, s60
  v_perm_b32 v124, v71, v67, s61
  s_waitcnt vmcnt(5)
  s_xor_b32 s57, s32, 0x20000
  buffer_load_dwordx4 v[48:51], v3, s[28:31], s57 offen offset:0 nt
  v_mfma_f32_16x16x32_bf16 v[232:235], v[200:203], v[8:11], v[232:235]
  v_fma_f32 v4, v154, s62, v32
  v_fma_f32 v5, v155, s62, v32
  v_exp_f32 v4, v4
  v_exp_f32 v5, v5
  s_nop 0
  v_cvt_pk_bf16_f32 v41, v4, v5
  v_add_f32 v31, v31, v4
  v_add_f32 v31, v31, v5
  s_waitcnt vmcnt(5)
  buffer_load_dwordx4 v[52:55], v3, s[28:31], s57 offen offset:512 nt
  v_mfma_f32_16x16x32_bf16 v[236:239], v[204:207], v[8:11], v[236:239]
  v_fma_f32 v4, v178, s62, v32
  v_fma_f32 v5, v179, s62, v32
  v_exp_f32 v4, v4
  v_exp_f32 v5, v5
  s_nop 0
  v_cvt_pk_bf16_f32 v45, v4, v5
  v_add_f32 v31, v31, v4
  v_add_f32 v31, v31, v5
  v_perm_b32 v97, v76, v72, s60
  v_perm_b32 v101, v76, v72, s61
  v_perm_b32 v105, v77, v73, s60
  v_perm_b32 v109, v77, v73, s61
  v_perm_b32 v113, v78, v74, s60
  v_perm_b32 v117, v78, v74, s61
  v_perm_b32 v121, v79, v75, s60
  v_perm_b32 v125, v79, v75, s61
  s_waitcnt vmcnt(5)
  buffer_load_dwordx4 v[56:59], v3, s[28:31], s57 offen offset:1024 nt
  v_mfma_f32_16x16x32_bf16 v[240:243], v[208:211], v[8:11], v[240:243]
  v_fma_f32 v4, v156, s62, v32
  v_fma_f32 v5, v157, s62, v32
  v_exp_f32 v4, v4
  v_exp_f32 v5, v5
  s_nop 0
  v_cvt_pk_bf16_f32 v42, v4, v5
  v_add_f32 v31, v31, v4
  v_add_f32 v31, v31, v5
  s_waitcnt vmcnt(5)
  buffer_load_dwordx4 v[60:63], v3, s[28:31], s57 offen offset:1536 nt
  v_mfma_f32_16x16x32_bf16 v[244:247], v[212:215], v[8:11], v[244:247]
  v_fma_f32 v4, v180, s62, v32
  v_fma_f32 v5, v181, s62, v32
  v_exp_f32 v4, v4
  v_exp_f32 v5, v5
  s_nop 0
  v_cvt_pk_bf16_f32 v46, v4, v5
  v_add_f32 v31, v31, v4
  v_add_f32 v31, v31, v5
  v_perm_b32 v98, v84, v80, s60
  v_perm_b32 v102, v84, v80, s61
  v_perm_b32 v106, v85, v81, s60
  v_perm_b32 v110, v85, v81, s61
  v_perm_b32 v114, v86, v82, s60
  v_perm_b32 v118, v86, v82, s61
  v_perm_b32 v122, v87, v83, s60
  v_perm_b32 v126, v87, v83, s61
  s_waitcnt vmcnt(5)
  s_xor_b32 s57, s32, 0x38000
  buffer_load_dwordx4 v[64:67], v3, s[28:31], s57 offen offset:0 nt
  v_mfma_f32_16x16x32_bf16 v[248:251], v[216:219], v[8:11], v[248:251]
  v_fma_f32 v4, v158, s62, v32
  v_fma_f32 v5, v159, s62, v32
  v_exp_f32 v4, v4
  v_exp_f32 v5, v5
  s_nop 0
  v_cvt_pk_bf16_f32 v43, v4, v5
  v_add_f32 v31, v31, v4
  v_add_f32 v31, v31, v5
  s_waitcnt vmcnt(5)
  buffer_load_dwordx4 v[68:71], v3, s[28:31], s57 offen offset:512 nt
  v_mfma_f32_16x16x32_bf16 v[252:255], v[220:223], v[8:11], v[252:255]
  v_fma_f32 v4, v182, s62, v32
  v_fma_f32 v5, v183, s62, v32
  v_exp_f32 v4, v4
  v_exp_f32 v5, v5
  s_nop 0
  v_cvt_pk_bf16_f32 v47, v4, v5
  v_add_f32 v31, v31, v4
  v_add_f32 v31, v31, v5
  v_perm_b32 v99, v92, v88, s60
  v_perm_b32 v103, v92, v88, s61
  v_perm_b32 v107, v93, v89, s60
  v_perm_b32 v111, v93, v89, s61
  v_perm_b32 v115, v94, v90, s60
  v_perm_b32 v119, v94, v90, s61
  v_perm_b32 v123, v95, v91, s60
  v_perm_b32 v127, v95, v91, s61
  s_waitcnt vmcnt(5)
  buffer_load_dwordx4 v[72:75], v3, s[28:31], s57 offen offset:1024 nt
  v_mfma_f32_16x16x32_bf16 v[224:227], v[96:99], v[40:43], v[224:227]
  v_fma_f32 v4, v160, s62, v32
  v_fma_f32 v5, v161, s62, v32
  v_exp_f32 v4, v4
  v_exp_f32 v5, v5
  s_nop 0
  v_cvt_pk_bf16_f32 v8, v4, v5
  v_add_f32 v31, v31, v4
  v_add_f32 v31, v31, v5
  s_waitcnt vmcnt(5)
  buffer_load_dwordx4 v[76:79], v3, s[28:31], s57 offen offset:1536 nt
  v_mfma_f32_16x16x32_bf16 v[228:231], v[100:103], v[40:43], v[228:231]
  v_fma_f32 v4, v184, s62, v32
  v_fma_f32 v5, v185, s62, v32
  v_exp_f32 v4, v4
  v_exp_f32 v5, v5
  s_nop 0
  v_cvt_pk_bf16_f32 v20, v4, v5
  v_add_f32 v31, v31, v4
  v_add_f32 v31, v31, v5
  v_perm_b32 v192, v52, v48, s60
  v_perm_b32 v196, v52, v48, s61
  v_perm_b32 v200, v53, v49, s60
  v_perm_b32 v204, v53, v49, s61
  v_perm_b32 v208, v54, v50, s60
  v_perm_b32 v212, v54, v50, s61
  v_perm_b32 v216, v55, v51, s60
  v_perm_b32 v220, v55, v51, s61
  s_waitcnt vmcnt(5)
  s_xor_b32 s57, s32, 0x28000
  buffer_load_dwordx4 v[80:83], v3, s[28:31], s57 offen offset:0 nt
  v_mfma_f32_16x16x32_bf16 v[232:235], v[104:107], v[40:43], v[232:235]
  v_fma_f32 v4, v162, s62, v32
  v_fma_f32 v5, v163, s62, v32
  v_exp_f32 v4, v4
  v_exp_f32 v5, v5
  s_nop 0
  v_cvt_pk_bf16_f32 v9, v4, v5
  v_add_f32 v31, v31, v4
  v_add_f32 v31, v31, v5
  s_waitcnt vmcnt(5)
  buffer_load_dwordx4 v[84:87], v3, s[28:31], s57 offen offset:512 nt
  v_mfma_f32_16x16x32_bf16 v[236:239], v[108:111], v[40:43], v[236:239]
  v_fma_f32 v4, v186, s62, v32
  v_fma_f32 v5, v187, s62, v32
  v_exp_f32 v4, v4
  v_exp_f32 v5, v5
  s_nop 0
  v_cvt_pk_bf16_f32 v21, v4, v5
  v_add_f32 v31, v31, v4
  v_add_f32 v31, v31, v5
  v_perm_b32 v193, v60, v56, s60
  v_perm_b32 v197, v60, v56, s61
  v_perm_b32 v201, v61, v57, s60
  v_perm_b32 v205, v61, v57, s61
  v_perm_b32 v209, v62, v58, s60
  v_perm_b32 v213, v62, v58, s61
  v_perm_b32 v217, v63, v59, s60
  v_perm_b32 v221, v63, v59, s61
  s_waitcnt vmcnt(5)
  buffer_load_dwordx4 v[88:91], v3, s[28:31], s57 offen offset:1024 nt
  v_mfma_f32_16x16x32_bf16 v[240:243], v[112:115], v[40:43], v[240:243]
  v_fma_f32 v4, v164, s62, v32
  v_fma_f32 v5, v165, s62, v32
  v_exp_f32 v4, v4
  v_exp_f32 v5, v5
  s_nop 0
  v_cvt_pk_bf16_f32 v10, v4, v5
  v_add_f32 v31, v31, v4
  v_add_f32 v31, v31, v5
  s_waitcnt vmcnt(5)
  buffer_load_dwordx4 v[92:95], v3, s[28:31], s57 offen offset:1536 nt
  v_mfma_f32_16x16x32_bf16 v[244:247], v[116:119], v[40:43], v[244:247]
  v_fma_f32 v4, v188, s62, v32
  v_fma_f32 v5, v189, s62, v32
  v_exp_f32 v4, v4
  v_exp_f32 v5, v5
  s_nop 0
  v_cvt_pk_bf16_f32 v22, v4, v5
  v_add_f32 v31, v31, v4
  v_add_f32 v31, v31, v5
  v_perm_b32 v194, v68, v64, s60
  v_perm_b32 v198, v68, v64, s61
  v_perm_b32 v202, v69, v65, s60
  v_perm_b32 v206, v69, v65, s61
  v_perm_b32 v210, v70, v66, s60
  v_perm_b32 v214, v70, v66, s61
  v_perm_b32 v218, v71, v67, s60
  v_perm_b32 v222, v71, v67, s61
  s_waitcnt vmcnt(5)
  s_xor_b32 s57, s32, 0x30000
  buffer_load_dwordx4 v[128:131], v3, s[28:31], s57 offen offset:0 nt
  v_mfma_f32_16x16x32_bf16 v[248:251], v[120:123], v[40:43], v[248:251]
  v_fma_f32 v4, v166, s62, v32
  v_fma_f32 v5, v167, s62, v32
  v_exp_f32 v4, v4
  v_exp_f32 v5, v5
  s_nop 0
  v_cvt_pk_bf16_f32 v11, v4, v5
  v_add_f32 v31, v31, v4
  v_add_f32 v31, v31, v5
  s_waitcnt vmcnt(5)
  buffer_load_dwordx4 v[132:135], v3, s[28:31], s57 offen offset:512 nt
  v_mfma_f32_16x16x32_bf16 v[252:255], v[124:127], v[40:43], v[252:255]
  v_fma_f32 v4, v190, s62, v32
  v_fma_f32 v5, v191, s62, v32
  v_exp_f32 v4, v4
  v_exp_f32 v5, v5
  s_nop 0
  v_cvt_pk_bf16_f32 v23, v4, v5
  v_add_f32 v31, v31, v4
  v_add_f32 v31, v31, v5
  v_perm_b32 v195, v76, v72, s60
  v_perm_b32 v199, v76, v72, s61
  v_perm_b32 v203, v77, v73, s60
  v_perm_b32 v207, v77, v73, s61
  v_perm_b32 v211, v78, v74, s60
  v_perm_b32 v215, v78, v74, s61
  v_perm_b32 v219, v79, v75, s60
  v_perm_b32 v223, v79, v75, s61
  s_waitcnt vmcnt(5)
  buffer_load_dwordx4 v[136:139], v3, s[28:31], s57 offen offset:1024 nt
  v_mfma_f32_16x16x32_bf16 v[224:227], v[192:195], v[8:11], v[224:227]
  v_fma_f32 v4, v168, s62, v32
  v_fma_f32 v5, v169, s62, v32
  v_exp_f32 v4, v4
  v_exp_f32 v5, v5
  s_nop 0
  v_cvt_pk_bf16_f32 v40, v4, v5
  v_add_f32 v31, v31, v4
  v_add_f32 v31, v31, v5
  s_waitcnt vmcnt(5)
  buffer_load_dwordx4 v[140:143], v3, s[28:31], s57 offen offset:1536 nt
  v_mfma_f32_16x16x32_bf16 v[228:231], v[196:199], v[8:11], v[228:231]
  v_perm_b32 v96, v84, v80, s60
  v_perm_b32 v100, v84, v80, s61
  v_perm_b32 v104, v85, v81, s60
  v_perm_b32 v108, v85, v81, s61
  v_perm_b32 v112, v86, v82, s60
  v_perm_b32 v116, v86, v82, s61
  v_perm_b32 v120, v87, v83, s60
  v_perm_b32 v124, v87, v83, s61
  s_waitcnt vmcnt(5)
  s_xor_b32 s57, s32, 0xac000
  buffer_load_dwordx4 v[144:147], v3, s[28:31], s57 offen offset:0 nt
  v_mfma_f32_16x16x32_bf16 v[232:235], v[200:203], v[8:11], v[232:235]
  v_fma_f32 v4, v170, s62, v32
  v_fma_f32 v5, v171, s62, v32
  v_exp_f32 v4, v4
  v_exp_f32 v5, v5
  s_nop 0
  v_cvt_pk_bf16_f32 v41, v4, v5
  v_add_f32 v31, v31, v4
  v_add_f32 v31, v31, v5
  s_waitcnt vmcnt(5)
  buffer_load_dwordx4 v[148:151], v3, s[28:31], s57 offen offset:512 nt
  v_mfma_f32_16x16x32_bf16 v[236:239], v[204:207], v[8:11], v[236:239]
  v_perm_b32 v97, v92, v88, s60
  v_perm_b32 v101, v92, v88, s61
  v_perm_b32 v105, v93, v89, s60
  v_perm_b32 v109, v93, v89, s61
  v_perm_b32 v113, v94, v90, s60
  v_perm_b32 v117, v94, v90, s61
  v_perm_b32 v121, v95, v91, s60
  v_perm_b32 v125, v95, v91, s61
  s_waitcnt vmcnt(5)
  buffer_load_dwordx4 v[152:155], v3, s[28:31], s57 offen offset:1024 nt
  v_mfma_f32_16x16x32_bf16 v[240:243], v[208:211], v[8:11], v[240:243]
  v_fma_f32 v4, v172, s62, v32
  v_fma_f32 v5, v173, s62, v32
  v_exp_f32 v4, v4
  v_exp_f32 v5, v5
  s_nop 0
  v_cvt_pk_bf16_f32 v42, v4, v5
  v_add_f32 v31, v31, v4
  v_add_f32 v31, v31, v5
  s_waitcnt vmcnt(5)
  buffer_load_dwordx4 v[156:159], v3, s[28:31], s57 offen offset:1536 nt
  v_mfma_f32_16x16x32_bf16 v[244:247], v[212:215], v[8:11], v[244:247]
  v_perm_b32 v98, v132, v128, s60
  v_perm_b32 v102, v132, v128, s61
  v_perm_b32 v106, v133, v129, s60
  v_perm_b32 v110, v133, v129, s61
  v_perm_b32 v114, v134, v130, s60
  v_perm_b32 v118, v134, v130, s61
  v_perm_b32 v122, v135, v131, s60
  v_perm_b32 v126, v135, v131, s61
  s_waitcnt vmcnt(5)
  s_xor_b32 s57, s32, 0xb4000
  buffer_load_dwordx4 v[48:51], v3, s[28:31], s57 offen offset:0 nt
  buffer_load_dwordx4 v[52:55], v3, s[28:31], s57 offen offset:512 nt
  v_mfma_f32_16x16x32_bf16 v[248:251], v[216:219], v[8:11], v[248:251]
  v_fma_f32 v4, v174, s62, v32
  v_fma_f32 v5, v175, s62, v32
  v_exp_f32 v4, v4
  v_exp_f32 v5, v5
  s_nop 0
  v_cvt_pk_bf16_f32 v43, v4, v5
  v_add_f32 v31, v31, v4
  v_add_f32 v31, v31, v5
  s_waitcnt vmcnt(6)
  buffer_load_dwordx4 v[56:59], v3, s[28:31], s57 offen offset:1024 nt
  buffer_load_dwordx4 v[60:63], v3, s[28:31], s57 offen offset:1536 nt
  v_mfma_f32_16x16x32_bf16 v[252:255], v[220:223], v[8:11], v[252:255]
  v_perm_b32 v99, v140, v136, s60
  v_perm_b32 v103, v140, v136, s61
  v_perm_b32 v107, v141, v137, s60
  v_perm_b32 v111, v141, v137, s61
  v_perm_b32 v115, v142, v138, s60
  v_perm_b32 v119, v142, v138, s61
  v_perm_b32 v123, v143, v139, s60
  v_perm_b32 v127, v143, v139, s61
  s_waitcnt vmcnt(7)
  s_xor_b32 s57, s32, 0xa4000
  buffer_load_dwordx4 v[64:67], v3, s[28:31], s57 offen offset:0 nt
  buffer_load_dwordx4 v[68:71], v3, s[28:31], s57 offen offset:512 nt
  v_mfma_f32_16x16x32_bf16 v[224:227], v[96:99], v[40:43], v[224:227]
  v_mov_b32 v4, v31
  s_nop 1
  v_permlane16_swap_b32 v31, v4
  s_nop 0
  v_add_f32 v31, v31, v4
  v_mov_b32 v4, v31
  s_nop 1
  v_permlane32_swap_b32 v31, v4
  s_nop 0
  v_add_f32 v31, v31, v4
  v_add_u32 v4, s58, v0
  ds_write_b32 v4, v31 offset:128
  s_waitcnt vmcnt(8)
  buffer_load_dwordx4 v[72:75], v3, s[28:31], s57 offen offset:1024 nt
  buffer_load_dwordx4 v[76:79], v3, s[28:31], s57 offen offset:1536 nt
  v_mfma_f32_16x16x32_bf16 v[228:231], v[100:103], v[40:43], v[228:231]
  v_perm_b32 v192, v148, v144, s60
  v_perm_b32 v196, v148, v144, s61
  v_perm_b32 v200, v149, v145, s60
  v_perm_b32 v204, v149, v145, s61
  v_perm_b32 v208, v150, v146, s60
  v_perm_b32 v212, v150, v146, s61
  v_perm_b32 v216, v151, v147, s60
  v_perm_b32 v220, v151, v147, s61
  s_waitcnt vmcnt(9)
  s_xor_b32 s57, s32, 0xbc000
  buffer_load_dwordx4 v[80:83], v3, s[28:31], s57 offen offset:0 nt
  buffer_load_dwordx4 v[84:87], v3, s[28:31], s57 offen offset:512 nt
  s_mov_b32 s40, 1
  s_atomic_add s40, s[20:21], s43 glc
  s_mov_b32 s69, 0
  v_mfma_f32_16x16x32_bf16 v[232:235], v[104:107], v[40:43], v[232:235]
  s_waitcnt vmcnt(10)
  buffer_load_dwordx4 v[88:91], v3, s[28:31], s57 offen offset:1024 nt
  buffer_load_dwordx4 v[92:95], v3, s[28:31], s57 offen offset:1536 nt
  v_mfma_f32_16x16x32_bf16 v[236:239], v[108:111], v[40:43], v[236:239]
  v_perm_b32 v193, v156, v152, s60
  v_perm_b32 v197, v156, v152, s61
  v_perm_b32 v201, v157, v153, s60
  v_perm_b32 v205, v157, v153, s61
  v_perm_b32 v209, v158, v154, s60
  v_perm_b32 v213, v158, v154, s61
  v_perm_b32 v217, v159, v155, s60
  v_perm_b32 v221, v159, v155, s61
  s_waitcnt vmcnt(11)
  v_mfma_f32_16x16x32_bf16 v[240:243], v[112:115], v[40:43], v[240:243]
  s_waitcnt vmcnt(10)
  v_mfma_f32_16x16x32_bf16 v[244:247], v[116:119], v[40:43], v[244:247]
  v_perm_b32 v194, v52, v48, s60
  v_perm_b32 v198, v52, v48, s61
  v_perm_b32 v202, v53, v49, s60
  v_perm_b32 v206, v53, v49, s61
  v_perm_b32 v210, v54, v50, s60
  v_perm_b32 v214, v54, v50, s61
  v_perm_b32 v218, v55, v51, s60
  v_perm_b32 v222, v55, v51, s61
  s_waitcnt vmcnt(9)
  v_mfma_f32_16x16x32_bf16 v[248:251], v[120:123], v[40:43], v[248:251]
  s_waitcnt vmcnt(8)
  v_mfma_f32_16x16x32_bf16 v[252:255], v[124:127], v[40:43], v[252:255]
  v_perm_b32 v195, v60, v56, s60
  v_perm_b32 v199, v60, v56, s61
  v_perm_b32 v203, v61, v57, s60
  v_perm_b32 v207, v61, v57, s61
  v_perm_b32 v211, v62, v58, s60
  v_perm_b32 v215, v62, v58, s61
  v_perm_b32 v219, v63, v59, s60
  v_perm_b32 v223, v63, v59, s61
  v_mfma_f32_16x16x32_bf16 v[224:227], v[192:195], v[44:47], v[224:227]
  v_mfma_f32_16x16x32_bf16 v[228:231], v[196:199], v[44:47], v[228:231]
  v_mfma_f32_16x16x32_bf16 v[232:235], v[200:203], v[44:47], v[232:235]
  v_mfma_f32_16x16x32_bf16 v[236:239], v[204:207], v[44:47], v[236:239]
  v_mfma_f32_16x16x32_bf16 v[240:243], v[208:211], v[44:47], v[240:243]
  v_mfma_f32_16x16x32_bf16 v[244:247], v[212:215], v[44:47], v[244:247]
  v_mfma_f32_16x16x32_bf16 v[248:251], v[216:219], v[44:47], v[248:251]
  v_mfma_f32_16x16x32_bf16 v[252:255], v[220:223], v[44:47], v[252:255]
  s_waitcnt vmcnt(7)
  s_waitcnt vmcnt(6)
  v_perm_b32 v96, v68, v64, s60
  v_perm_b32 v100, v68, v64, s61
  v_perm_b32 v104, v69, v65, s60
  v_perm_b32 v108, v69, v65, s61
  v_perm_b32 v112, v70, v66, s60
  v_perm_b32 v116, v70, v66, s61
  v_perm_b32 v120, v71, v67, s60
  v_perm_b32 v124, v71, v67, s61
  s_waitcnt vmcnt(5)
  v_and_b32 v4, 28, v1
  v_lshl_add_u32 v3, v4, 20, v39
  s_waitcnt vmcnt(4)
  v_perm_b32 v97, v76, v72, s60
  v_perm_b32 v101, v76, v72, s61
  v_perm_b32 v105, v77, v73, s60
  v_perm_b32 v109, v77, v73, s61
  v_perm_b32 v113, v78, v74, s60
  v_perm_b32 v117, v78, v74, s61
  v_perm_b32 v121, v79, v75, s60
  v_perm_b32 v125, v79, v75, s61
  s_waitcnt vmcnt(3)
L_tick:
  s_waitcnt lgkmcnt(0)
  s_sub_u32 s40, s40, s42
  s_cmp_lt_u32 s40, 4
  s_cbranch_scc1 L_tick_ok
L_tick_retry:
  s_add_u32 s69, s69, 1
  s_cmp_ge_u32 s69, 0x40000
  s_cbranch_scc1 L_end
  s_mov_b32 s40, 0
  s_atomic_add s40, s[20:21], s43 glc
  s_waitcnt lgkmcnt(0)
  s_sub_u32 s40, s40, s42
  s_cmp_lt_u32 s40, 4
  s_cbranch_scc0 L_tick_retry
  s_mov_b32 s40, 1
  s_atomic_add s40, s[20:21], s43 glc
  s_branch L_tick
L_tick_ok:
  s_mov_b32 s69, 0
  s_cmp_eq_u32 s40, 3
  s_cselect_b32 s38, 0x200000, 0
  s_waitcnt vmcnt(2)
  v_perm_b32 v98, v84, v80, s60
  v_perm_b32 v102, v84, v80, s61
  v_perm_b32 v106, v85, v81, s60
  v_perm_b32 v110, v85, v81, s61
  v_perm_b32 v114, v86, v82, s60
  v_perm_b32 v118, v86, v82, s61
  v_perm_b32 v122, v87, v83, s60
  v_perm_b32 v126, v87, v83, s61
  s_waitcnt vmcnt(1)
  s_waitcnt vmcnt(0)
  v_perm_b32 v99, v92, v88, s60
  v_perm_b32 v103, v92, v88, s61
  v_perm_b32 v107, v93, v89, s60
  v_perm_b32 v111, v93, v89, s61
  v_mfma_f32_16x16x32_bf16 v[224:227], v[96:99], v[20:23], v[224:227]
  v_perm_b32 v115, v94, v90, s60
  v_mfma_f32_16x16x32_bf16 v[228:231], v[100:103], v[20:23], v[228:231]
  v_perm_b32 v119, v94, v90, s61
  v_mfma_f32_16x16x32_bf16 v[232:235], v[104:107], v[20:23], v[232:235]
  v_perm_b32 v123, v95, v91, s60
  v_mfma_f32_16x16x32_bf16 v[236:239], v[108:111], v[20:23], v[236:239]
  v_perm_b32 v127, v95, v91, s61
  v_mfma_f32_16x16x32_bf16 v[240:243], v[112:115], v[20:23], v[240:243]
  ds_write2_b32 v33, v224, v225 offset0:0 offset1:8
  ds_write2_b32 v33, v226, v227 offset0:16 offset1:24
  v_mfma_f32_16x16x32_bf16 v[244:247], v[116:119], v[20:23], v[244:247]
  ds_write2_b32 v33, v228, v229 offset0:1 offset1:9
  ds_write2_b32 v33, v230, v231 offset0:17 offset1:25
  v_mfma_f32_16x16x32_bf16 v[248:251], v[120:123], v[20:23], v[248:251]
  ds_write2_b32 v33, v232, v233 offset0:2 offset1:10
  ds_write2_b32 v33, v234, v235 offset0:18 offset1:26
  v_mfma_f32_16x16x32_bf16 v[252:255], v[124:127], v[20:23], v[252:255]
  ds_write2_b32 v33, v236, v237 offset0:3 offset1:11
  ds_write2_b32 v33, v238, v239 offset0:19 offset1:27
  ds_write2_b32 v33, v240, v241 offset0:4 offset1:12
  ds_write2_b32 v33, v242, v243 offset0:20 offset1:28
  ds_write2_b32 v33, v244, v245 offset0:5 offset1:13
  ds_write2_b32 v33, v246, v247 offset0:21 offset1:29
  ds_write2_b32 v33, v248, v249 offset0:6 offset1:14
  ds_write2_b32 v33, v250, v251 offset0:22 offset1:30
  ds_write2_b32 v33, v252, v253 offset0:7 offset1:15
  ds_write2_b32 v33, v254, v255 offset0:23 offset1:31
  s_mov_b32 s38, 0x200000
  s_cmp_eq_u32 s40, 3
  s_waitcnt lgkmcnt(0)
  s_barrier
  ds_read_b128 v[64:67], v38 offset:128
  ds_read_b128 v[48:51], v34 offset:0
  ds_read_b128 v[52:55], v34 offset:4224
  ds_read_b128 v[56:59], v34 offset:8448
  ds_read_b128 v[60:63], v34 offset:12672
  s_cbranch_scc1 L_final
  s_waitcnt lgkmcnt(4)
  v_pk_add_f32 v[64:65], v[64:65], v[66:67]
  s_waitcnt lgkmcnt(2)
  v_pk_add_f32 v[48:49], v[48:49], v[52:53]
  v_pk_add_f32 v[50:51], v[50:51], v[54:55]
  v_add_f32 v18, v64, v65
  buffer_store_dwordx4 v[16:19], v3, s[36:39], s67 offen offset:1024 sc1
  s_waitcnt lgkmcnt(0)
  v_pk_add_f32 v[58:59], v[58:59], v[62:63]
  v_pk_add_f32 v[56:57], v[56:57], v[60:61]
  v_pk_add_f32 v[14:15], v[50:51], v[58:59]
  v_pk_add_f32 v[12:13], v[48:49], v[56:57]
  v_and_or_b32 v15, v15, s68, v29
  v_and_or_b32 v13, v13, s68, v2
  buffer_store_dwordx4 v[12:15], v36, s[36:39], s67 offen sc1
  s_endpgm
L_final:
  buffer_load_dwordx4 v[160:163], v36, s[36:39], s64 offen sc1
  buffer_load_dwordx4 v[164:167], v36, s[36:39], s66 offen sc1
  buffer_load_dwordx4 v[168:171], v36, s[36:39], s65 offen sc1
  buffer_load_dwordx4 v[172:175], v39, s[36:39], s64 offen offset:1024 sc1
  buffer_load_dwordx4 v[176:179], v39, s[36:39], s66 offen offset:1024 sc1
  buffer_load_dwordx4 v[180:183], v39, s[36:39], s65 offen offset:1024 sc1
  s_waitcnt lgkmcnt(4)
  v_pk_add_f32 v[64:65], v[64:65], v[66:67]
  s_waitcnt lgkmcnt(2)
  v_pk_add_f32 v[48:49], v[48:49], v[52:53]
  v_pk_add_f32 v[50:51], v[50:51], v[54:55]
  v_add_f32 v18, v64, v65
  s_waitcnt lgkmcnt(0)
  v_pk_add_f32 v[58:59], v[58:59], v[62:63]
  v_pk_add_f32 v[56:57], v[56:57], v[60:61]
  v_pk_add_f32 v[14:15], v[50:51], v[58:59]
  v_pk_add_f32 v[12:13], v[48:49], v[56:57]
  v_and_or_b32 v15, v15, s68, v29
  v_and_or_b32 v13, v13, s68, v2
  v_xor_b32 v13, s35, v13
  v_xor_b32 v15, v15, v29
  s_branch L_check
L_poll:
  buffer_load_dwordx4 v[160:163], v36, s[36:39], s64 offen sc1
  buffer_load_dwordx4 v[164:167], v36, s[36:39], s66 offen sc1
  buffer_load_dwordx4 v[168:171], v36, s[36:39], s65 offen sc1
  buffer_load_dwordx4 v[172:175], v39, s[36:39], s64 offen offset:1024 sc1
  buffer_load_dwordx4 v[176:179], v39, s[36:39], s66 offen offset:1024 sc1
  buffer_load_dwordx4 v[180:183], v39, s[36:39], s65 offen offset:1024 sc1
L_check:
  s_add_u32 s69, s69, 1
  s_cmp_ge_u32 s69, 0x80000
  s_cbranch_scc1 L_end
  s_waitcnt vmcnt(0)
  v_xor_b32 v163, v163, v29
  v_xor_b32 v167, v167, v29
  v_xor_b32 v171, v171, v29
  v_xor_b32 v161, s35, v161
  v_xor_b32 v165, s35, v165
  v_xor_b32 v169, s35, v169
  v_bitop3_b32 v8, v173, v175, s63 bitop3:0x7e
  v_bitop3_b32 v9, v177, v179, s63 bitop3:0x7e
  v_bitop3_b32 v10, v181, v183, s63 bitop3:0x7e
  v_or3_b32 v4, v163, v167, v171
  v_or3_b32 v5, v161, v165, v169
  v_or3_b32 v8, v8, v9, v10
  v_max3_f32 v6, v16, v172, v176
  v_bitop3_b32 v4, v4, v5, s68 bitop3:0x54
  v_max3_f32 v6, v6, v180, v28
  v_or_b32 v4, v4, v8
  v_cmp_ne_u32 vcc, 0, v4
  v_sub_f32 v8, v16, v6
  v_sub_f32 v10, v28, v6
  s_cbranch_vccnz L_poll
  v_exp_f32 v16, v8
  v_sub_f32 v172, v172, v6
  v_sub_f32 v176, v176, v6
  v_sub_f32 v180, v180, v6
  v_exp_f32 v28, v10
  v_exp_f32 v172, v172
  v_exp_f32 v176, v176
  v_exp_f32 v180, v180
  v_mul_f32 v18, v16, v18
  v_mul_f32 v174, v172, v174
  v_mul_f32 v178, v176, v178
  v_mul_f32 v182, v180, v182
  v_add_f32 v6, v18, v174
  v_add_f32 v7, v178, v182
  v_pk_mul_f32 v[12:13], v[16:17], v[12:13] op_sel_hi:[0,1]
  v_pk_mul_f32 v[160:161], v[172:173], v[160:161] op_sel_hi:[0,1]
  v_add_f32 v6, v6, v7
  v_pk_mul_f32 v[164:165], v[176:177], v[164:165] op_sel_hi:[0,1]
  v_pk_mul_f32 v[168:169], v[180:181], v[168:169] op_sel_hi:[0,1]
  v_add_f32 v6, v6, v28
  v_pk_mul_f32 v[14:15], v[16:17], v[14:15] op_sel_hi:[0,1]
  v_pk_mul_f32 v[162:163], v[172:173], v[162:163] op_sel_hi:[0,1]
  v_rcp_f32 v6, v6
  v_pk_mul_f32 v[166:167], v[176:177], v[166:167] op_sel_hi:[0,1]
  v_pk_mul_f32 v[170:171], v[180:181], v[170:171] op_sel_hi:[0,1]
  v_pk_add_f32 v[12:13], v[12:13], v[160:161]
  v_pk_add_f32 v[164:165], v[164:165], v[168:169]
  v_pk_add_f32 v[14:15], v[14:15], v[162:163]
  v_pk_add_f32 v[166:167], v[166:167], v[170:171]
  v_pk_add_f32 v[12:13], v[12:13], v[164:165]
  v_pk_add_f32 v[14:15], v[14:15], v[166:167]
  v_pk_fma_f32 v[12:13], v[28:29], v[24:25], v[12:13] op_sel_hi:[0,1,1]
  v_pk_fma_f32 v[14:15], v[28:29], v[26:27], v[14:15] op_sel_hi:[0,1,1]
  v_pk_mul_f32 v[12:13], v[6:7], v[12:13] op_sel_hi:[0,1]
  v_pk_mul_f32 v[14:15], v[6:7], v[14:15] op_sel_hi:[0,1]
  v_cvt_pk_bf16_f32 v4, v12, v13
  v_cvt_pk_bf16_f32 v5, v14, v15
  buffer_store_dwordx2 v[4:5], v37, s[44:47], 0 offen
L_end:
  s_endpgm
.section .rodata,"a"
.p2align 6
.amdhsa_kernel standalone__tree_speculative_verify_tree_attention_over_candidate_token_tree__sampling_kernel
  .amdhsa_next_free_vgpr 256
  .amdhsa_next_free_sgpr 72
  .amdhsa_accum_offset 256
  .amdhsa_group_segment_fixed_size 0
  .amdhsa_kernarg_size 72
  .amdhsa_user_sgpr_count 2
  .amdhsa_user_sgpr_kernarg_segment_ptr 1
  .amdhsa_system_sgpr_workgroup_id_x 1
  .amdhsa_float_denorm_mode_32 3
.end_amdhsa_kernel
```
